```python
import torch

def _softmax(x, axis=-1):
    return torch.softmax(x, dim=axis)
def _gelu(x):
    return torch.nn.functional.gelu(x, approximate="tanh")
def _silu(x):
    return torch.nn.functional.silu(x)
def _sigmoid(x):
    return torch.sigmoid(x)
def _layernorm(x, axis=-1, eps=1e-5):
    m = x.mean(dim=axis, keepdim=True)
    v = x.var(dim=axis, keepdim=True, unbiased=False)
    return (x - m) / torch.sqrt(v + eps)
def _scatter_add(tgt, idx, src, axis=0):
    return tgt.clone().index_add_(axis, idx, src)
def _segment_sum(src, seg, n):
    out = torch.zeros((n,) + src.shape[1:], dtype=src.dtype)
    return out.index_add_(0, seg, src)
def _pad(x, pw):
    flat = tuple(v for pair in reversed(pw) for v in pair)
    return torch.nn.functional.pad(x, flat)

kernel_name = 'concat_heads__sliding_block__sliding_local_dilated__prompt'

def setup_inputs():

    _w = (lambda a: (lambda t: t.to(torch.bfloat16) if t.is_floating_point() else t)(torch.as_tensor(a)))
    def _A_setup():
        B, S, D = 1, 2048, 448
        return {
            "x": _w((lambda *s: torch.randn(*s, dtype=torch.bfloat16) * 0.2)(B, S, D)),
            "wqkv": _w((lambda *s: torch.randn(*s, dtype=torch.bfloat16) * 0.4)(D, 3 * D)),
            "wo": _w((lambda *s: torch.randn(*s, dtype=torch.bfloat16) * 0.4)(D, D)),
        }
    _A_in = _A_setup()

    def _B_setup():
        B, S, D = 1, 2048, 448
        return {
            "x": _w((lambda *s: torch.randn(*s, dtype=torch.bfloat16) * 0.2)(B, S, D)),
            "wqkv": _w((lambda *s: torch.randn(*s, dtype=torch.bfloat16) * 0.4)(D, 3 * D)),
            "wo": _w((lambda *s: torch.randn(*s, dtype=torch.bfloat16) * 0.4)(D, D)),
        }
    _B_in = _B_setup()

    return {
        "A_x": _A_in["x"],
        "A_wqkv": _A_in["wqkv"],
        "A_wo": _A_in["wo"],
        "B_x": _B_in["x"],
        "B_wqkv": _B_in["wqkv"],
        "B_wo": _B_in["wo"],
    }

def reference(A_x, A_wqkv, A_wo, B_x, B_wqkv, B_wo):
    def _A_ref(x, wqkv, wo):
        B, S, D = x.shape
        H = 16; Dh = D // H; W = 256
        qkv = (lambda x, *d: x.permute(*d))((x @ wqkv).reshape(B, S, 3, H, Dh), 2, 0, 3, 1, 4)
        q, k, v = qkv[0], qkv[1], qkv[2]
        scores = torch.einsum("bhqd,bhkd->bhqk", q, k) * (Dh ** -0.5)
        idx = torch.arange(S)
        mask = (idx[:, None] - idx[None, :] >= 0) & (idx[:, None] - idx[None, :] < W)
        scores = torch.where(mask[None, None], scores, -1e9)
        p = _softmax(scores, axis=-1)
        o = torch.einsum("bhqk,bhkd->bhqd", p, v)
        return (lambda x, *d: x.permute(*d))(o, 0, 2, 1, 3).reshape(B, S, D) @ wo

    def _B_ref(x, wqkv, wo):
        B, S, D = x.shape
        H = 16; Dh = D // H
        W, dil = 8, 2
        qkv = (lambda x, *d: x.permute(*d))((x @ wqkv).reshape(B, S, 3, H, Dh), 2, 0, 3, 1, 4)
        q, k, v = qkv[0], qkv[1], qkv[2]
        scale = Dh ** -0.5
        pos = torch.arange(S)
        off = torch.arange(W) * dil
        idx = pos[:, None] - off[None, :]
        mask = idx >= 0
        idx_c = torch.where(mask, idx, 0).reshape(-1)
        kg = k[:, :, idx_c, :].reshape(B, H, S, W, Dh)
        vg = v[:, :, idx_c, :].reshape(B, H, S, W, Dh)
        logits = torch.einsum("bhsd,bhswd->bhsw", q, kg) * scale
        logits = torch.where(mask[None, None, :, :], logits, -1e9)
        attn = _softmax(logits, axis=-1)
        o = torch.einsum("bhsw,bhswd->bhsd", attn, vg)
        return (lambda x, *d: x.permute(*d))(o, 0, 2, 1, 3).reshape(B, S, D) @ wo

    a = _A_ref(A_x, A_wqkv, A_wo)
    b = _B_ref(B_x, B_wqkv, B_wo)
    return torch.concatenate([a, b], axis=-1)
```

```asm
; @launch grid=(256,1,1) block=(512,1,1) lds=163840
.amdgcn_target "amdgcn-amd-amdhsa--gfx950"
.text
.globl concat_heads__sliding_block__sliding_local_dilated__prompt_kernel
.p2align 8
.type concat_heads__sliding_block__sliding_local_dilated__prompt_kernel,@function
concat_heads__sliding_block__sliding_local_dilated__prompt_kernel:
    s_cmp_ge_u32 s2, 256
    s_cbranch_scc1 L_end
    s_load_dwordx16 s[32:47], s[0:1], 0
    s_load_dwordx2 s[48:49], s[0:1], 64
    v_lshrrev_b32 v10, 6, v0
    v_and_b32 v1, 63, v0
    v_readfirstlane_b32 s31, v10
    s_lshr_b32 s28, s2, 7
    s_bfe_u32 s64, s2, 0x20003
    s_bfe_u32 s65, s2, 0x20005
    s_and_b32 s29, s2, 1
    s_lshl_b32 s29, s29, 2
    s_add_u32 s29, s29, s64
    s_bfe_u32 s30, s2, 0x20001
    s_lshl_b32 s30, s30, 2
    s_add_u32 s30, s30, s65
    s_and_b32 s55, s31, 3
    s_cmp_lg_u32 s31, 0
    s_cbranch_scc1 L_nz_1
    v_and_b32 v10, 7, v1
    v_and_b32 v11, 2, v10
    v_lshlrev_b32 v11, 5, v11
    v_lshlrev_b32 v10, 7, v10
    v_sub_u32 v10, v10, v11
    v_add_u32 v10, 97392, v10
    v_mov_b32 v32, 0
    v_mov_b32 v33, 0
    v_mov_b32 v34, 0
    v_mov_b32 v35, 0
    s_mov_b64 exec, 0xff
    ds_write_b128 v10, v[32:35]
    s_mov_b64 exec, -1
L_nz_1:
    v_lshrrev_b32 v10, 3, v1
    v_lshrrev_b32 v11, 4, v1
    v_xor_b32 v11, v11, v1
    v_and_b32 v11, 7, v11
    v_mul_u32_u24 v12, 896, v10
    v_lshl_add_u32 v16, v11, 4, v12
    v_xor_b32 v13, 64, v16
    v_add_u32 v17, 6144, v13
    v_add_u32 v18, 12288, v16
    v_add_u32 v19, 18432, v13
    v_lshrrev_b32 v11, 2, v1
    v_and_b32 v11, 4, v11
    v_and_b32 v12, 7, v1
    v_xor_b32 v11, v11, v12
    v_min_u32 v11, 6, v11
    v_mul_u32_u24 v12, 2688, v10
    v_lshl_add_u32 v12, v11, 4, v12
    v_add_u32 v20, 4992, v12
    v_add_u32 v21, 25472, v12
    v_add_u32 v22, 3840, v12
    v_add_u32 v23, 24320, v12
    v_add_u32 v24, 4096, v12
    v_add_u32 v25, 24576, v12
    s_mul_i32 s54, s30, 114688
    s_mul_i32 s63, s55, 28672
    s_add_u32 s54, s54, s63
    s_mul_i32 s56, s29, 112
    s_mul_i32 s63, s55, 43008
    s_add_u32 s56, s56, s63
    s_lshl_b32 s57, s55, 12
    s_lshl_b32 s58, s55, 11
    v_and_b32 v10, 3, v1
    v_and_b32 v244, 2, v10
    v_lshlrev_b32 v244, 5, v244
    v_lshlrev_b32 v10, 7, v10
    v_sub_u32 v244, v10, v244
    v_add_u32 v244, 97400, v244
    v_mov_b32 v249, 97280
    v_mov_b32 v250, 0x7ffffff0
    v_mov_b32 v247, 1
    v_cmp_eq_u32 vcc, 0, v1
    s_lshl_b32 s62, s55, 7
    s_and_b32 s63, s55, 2
    s_lshl_b32 s63, s63, 5
    s_sub_u32 s62, s62, s63
    s_cmp_lt_u32 s31, 4
    s_cselect_b32 s63, 512, 0
    s_add_u32 s62, s62, s63
    s_add_u32 s62, s62, 120
    v_cndmask_b32 v250, v250, v249, vcc
    v_add_u32 v245, s62, v250
    v_and_b32 v10, 31, v1
    v_bfe_u32 v11, v1, 1, 3
    v_lshrrev_b32 v12, 5, v1
    v_xor_b32 v11, v11, v12
    v_lshlrev_b32 v10, 7, v10
    v_add_u32 v10, s57, v10
    v_lshl_add_u32 v4, v11, 4, v10
    v_xor_b32 v5, 32, v4
    v_xor_b32 v6, 64, v4
    v_xor_b32 v7, 96, v4
    s_mov_b32 s6, 0x1c0000
    s_mov_b32 s7, 0x20000
    s_mov_b32 s10, 0x127000
    s_mov_b32 s11, 0x20000
    s_cmp_eq_u32 s28, 0
    s_waitcnt lgkmcnt(0)
    s_cselect_b32 s4, s32, s38
    s_cselect_b32 s5, s33, s39
    s_cselect_b32 s8, s34, s40
    s_cselect_b32 s9, s35, s41
    s_sub_u32 s8, s8, 4096
    s_subb_u32 s9, s9, 0
    s_cmp_lt_u32 s31, 4
    s_cbranch_scc1 L_noiss0
    s_add_u32 m0, s57, 0
    s_nop 0
    buffer_load_dwordx4 v16, s[4:7], s54 offen lds
    buffer_load_dwordx4 v17, s[4:7], s54 offen offset:1024 lds
    buffer_load_dwordx4 v18, s[4:7], s54 offen offset:2048 lds
    buffer_load_dwordx4 v19, s[4:7], s54 offen offset:3072 lds
    s_add_u32 m0, s57, 16384
    s_mov_b32 s53, s56
    buffer_load_dwordx4 v20, s[8:11], s56 offen lds
    buffer_load_dwordx4 v21, s[8:11], s56 offen offset:1024 lds
    buffer_load_dwordx4 v22, s[8:11], s56 offen offset:2048 lds
    buffer_load_dwordx4 v23, s[8:11], s56 offen offset:3072 lds
L_noiss0:
    s_barrier
    s_cmp_lt_u32 s31, 4
    s_cbranch_scc1 L_noiss
    s_add_u32 m0, s57, 32768
    s_add_u32 s54, s54, 128
    buffer_load_dwordx4 v16, s[4:7], s54 offen lds
    buffer_load_dwordx4 v17, s[4:7], s54 offen offset:1024 lds
    buffer_load_dwordx4 v18, s[4:7], s54 offen offset:2048 lds
    buffer_load_dwordx4 v19, s[4:7], s54 offen offset:3072 lds
    s_add_u32 m0, s57, 49152
    s_add_u32 s56, s56, 172032
    buffer_load_dwordx4 v20, s[8:11], s56 offen lds
    buffer_load_dwordx4 v21, s[8:11], s56 offen offset:1024 lds
    buffer_load_dwordx4 v22, s[8:11], s56 offen offset:2048 lds
    buffer_load_dwordx4 v23, s[8:11], s56 offen offset:3072 lds
L_noiss:
    s_cmp_eq_u32 s28, 0
    s_cbranch_scc1 L_A
    s_cmp_lt_u32 s31, 4
    s_cbranch_scc1 L_consB
    s_mov_b32 s38, 0xf7f77f7f
    s_mov_b32 s39, 0xf7f77f7f
    s_cmp_eq_u32 s31, 7
    s_cselect_b64 s[38:39], s[38:39], -1
    s_waitcnt vmcnt(8)
    ds_add_u32 v245, v247 offset:0
    ds_read_b128 v[128:131], v4 offset:0
    ds_read_b128 v[132:135], v5 offset:0
    ds_read_b128 v[136:139], v6 offset:0
    ds_read_b128 v[140:143], v7 offset:0
    s_add_u32 m0, s57, 65536
    s_add_u32 s54, s54, 128
    buffer_load_dwordx4 v16, s[4:7], s54 offen lds
    buffer_load_dwordx4 v17, s[4:7], s54 offen offset:1024 lds
    buffer_load_dwordx4 v18, s[4:7], s54 offen offset:2048 lds
    buffer_load_dwordx4 v19, s[4:7], s54 offen offset:3072 lds
    s_add_u32 m0, s57, 81920
    s_add_u32 s56, s56, 172032
    buffer_load_dwordx4 v20, s[8:11], s56 offen lds
    buffer_load_dwordx4 v21, s[8:11], s56 offen offset:1024 lds
    buffer_load_dwordx4 v22, s[8:11], s56 offen offset:2048 lds
    s_mov_b64 exec, s[38:39]
    buffer_load_dwordx4 v23, s[8:11], s56 offen offset:3072 lds
    s_mov_b64 exec, -1
    v_add_u32 v64, 0x10000, v4
    v_add_u32 v65, 0x10000, v5
    v_add_u32 v66, 0x10000, v6
    v_add_u32 v67, 0x10000, v7
    v_add_u32 v68, 0x20000, v4
    v_add_u32 v69, 0x20000, v5
    v_add_u32 v70, 0x20000, v6
    v_add_u32 v71, 0x20000, v7
    s_mov_b32 s24, s46
    s_mov_b32 s25, s47
    s_mov_b32 s26, 256
    s_mov_b32 s27, 0x20000
    v_mov_b32 v15, 0
    v_lshlrev_b32 v9, 4, v1
    s_cmp_eq_u32 s28, 0
    s_cselect_b32 s12, s36, s42
    s_cselect_b32 s13, s37, s43
    s_mov_b32 s14, 0x62000
    s_mov_b32 s15, 0x20000
    s_mov_b32 s16, s48
    s_mov_b32 s17, s49
    s_mov_b32 s18, 0x2400000
    s_mov_b32 s19, 0x20000
    s_mov_b32 s20, s44
    s_mov_b32 s21, s45
    s_mov_b32 s22, 0x380000
    s_mov_b32 s23, 0x20000
    s_mov_b32 s68, 0
    s_mov_b32 s69, -1
    s_mov_b32 s66, 0x3e8b97f6
    s_lshl_b32 s52, s31, 10
    s_lshr_b32 s51, s31, 2
    s_sub_u32 s63, 3, s55
    s_cmp_lt_u32 s31, 4
    s_cselect_b32 s50, s63, s55
    s_lshl_b32 s59, s28, 3
    s_add_u32 s59, s59, s29
    s_lshl_b32 s59, s59, 4
    s_add_u32 s59, s59, s30
    s_mul_i32 s37, s59, 33280
    s_lshl_b32 s59, s59, 15
    s_and_b32 s32, s29, 3
    s_lshr_b32 s62, s29, 2
    s_lshl_b32 s33, s30, 1
    s_add_u32 s33, s33, s62
    s_mul_i32 s34, s31, 3584
    s_lshl_b32 s62, s32, 8
    s_add_u32 s34, s34, s62
    s_waitcnt vmcnt(8)
    s_waitcnt lgkmcnt(0)
    ds_add_u32 v245, v247 offset:0
    ds_read_b128 v[144:147], v4 offset:32768
    ds_read_b128 v[148:151], v5 offset:32768
    ds_read_b128 v[152:155], v6 offset:32768
    ds_read_b128 v[156:159], v7 offset:32768
    s_add_u32 m0, s57, 98304
    s_add_u32 s54, s54, 128
    buffer_load_dwordx4 v16, s[4:7], s54 offen lds
    buffer_load_dwordx4 v17, s[4:7], s54 offen offset:1024 lds
    buffer_load_dwordx4 v18, s[4:7], s54 offen offset:2048 lds
    buffer_load_dwordx4 v19, s[4:7], s54 offen offset:3072 lds
    s_add_u32 m0, s57, 114688
    s_add_u32 s56, s56, 172032
    buffer_load_dwordx4 v20, s[8:11], s56 offen lds
    buffer_load_dwordx4 v21, s[8:11], s56 offen offset:1024 lds
    buffer_load_dwordx4 v22, s[8:11], s56 offen offset:2048 lds
    buffer_load_dwordx4 v23, s[8:11], s56 offen offset:3072 lds
    v_bfe_u32 v10, v1, 2, 2
    v_lshrrev_b32 v12, 5, v1
    v_lshl_add_u32 v11, v12, 3, v10
    v_lshlrev_b32 v11, 7, v11
    v_lshrrev_b32 v10, 1, v10
    v_lshlrev_b32 v10, 6, v10
    v_and_b32 v12, 3, v1
    v_lshlrev_b32 v12, 3, v12
    v_and_b32 v8, 16, v1
    v_lshl_add_u32 v12, v8, 1, v12
    v_add_u32 v12, 0, v12
    v_xor_b32 v12, v12, v10
    v_add_u32 v8, v11, v12
    v_add_u32 v8, 65536, v8
    v_bfe_u32 v10, v1, 2, 2
    v_lshrrev_b32 v12, 5, v1
    v_lshl_add_u32 v11, v12, 3, v10
    v_lshlrev_b32 v11, 7, v11
    v_lshrrev_b32 v10, 1, v10
    v_lshlrev_b32 v10, 6, v10
    v_and_b32 v12, 3, v1
    v_lshlrev_b32 v12, 3, v12
    v_and_b32 v3, 16, v1
    v_lshl_add_u32 v12, v3, 1, v12
    v_add_u32 v12, 56, v12
    v_xor_b32 v12, v12, v10
    v_add_u32 v3, v11, v12
    v_add_u32 v3, 65536, v3
    v_mov_b32 v10, 0xf149f2ca
    s_mov_b32 s64, 0x00005555
    s_mov_b32 s65, 0x00055550
    v_cndmask_b32 v96, v10, 0, s[64:65]
    s_mov_b32 s64, 0x00000000
    s_mov_b32 s65, 0x00000000
    v_cndmask_b32 v112, v10, 0, s[64:65]
    s_mov_b32 s64, 0x0000aaaa
    s_mov_b32 s65, 0x000aaaa0
    v_cndmask_b32 v97, v10, 0, s[64:65]
    s_mov_b32 s64, 0x00000000
    s_mov_b32 s65, 0x00000000
    v_cndmask_b32 v113, v10, 0, s[64:65]
    s_mov_b32 s64, 0x00015554
    s_mov_b32 s65, 0x00155540
    v_cndmask_b32 v98, v10, 0, s[64:65]
    s_mov_b32 s64, 0x00000000
    s_mov_b32 s65, 0x00000000
    v_cndmask_b32 v114, v10, 0, s[64:65]
    s_mov_b32 s64, 0x0002aaa8
    s_mov_b32 s65, 0x002aaa80
    v_cndmask_b32 v99, v10, 0, s[64:65]
    s_mov_b32 s64, 0x00000000
    s_mov_b32 s65, 0x00000000
    v_cndmask_b32 v115, v10, 0, s[64:65]
    s_mov_b32 s64, 0x00555500
    s_mov_b32 s65, 0x05555000
    v_cndmask_b32 v100, v10, 0, s[64:65]
    s_mov_b32 s64, 0x00000000
    s_mov_b32 s65, 0x00000000
    v_cndmask_b32 v116, v10, 0, s[64:65]
    s_mov_b32 s64, 0x00aaaa00
    s_mov_b32 s65, 0x0aaaa000
    v_cndmask_b32 v101, v10, 0, s[64:65]
    s_mov_b32 s64, 0x00000000
    s_mov_b32 s65, 0x00000000
    v_cndmask_b32 v117, v10, 0, s[64:65]
    s_mov_b32 s64, 0x01555400
    s_mov_b32 s65, 0x15554000
    v_cndmask_b32 v102, v10, 0, s[64:65]
    s_mov_b32 s64, 0x00000000
    s_mov_b32 s65, 0x00000000
    v_cndmask_b32 v118, v10, 0, s[64:65]
    s_mov_b32 s64, 0x02aaa800
    s_mov_b32 s65, 0x2aaa8000
    v_cndmask_b32 v103, v10, 0, s[64:65]
    s_mov_b32 s64, 0x00000000
    s_mov_b32 s65, 0x00000000
    v_cndmask_b32 v119, v10, 0, s[64:65]
    s_mov_b32 s64, 0x55550000
    s_mov_b32 s65, 0x55500000
    v_cndmask_b32 v104, v10, 0, s[64:65]
    s_mov_b32 s64, 0x00000000
    s_mov_b32 s65, 0x00000005
    v_cndmask_b32 v120, v10, 0, s[64:65]
    s_mov_b32 s64, 0xaaaa0000
    s_mov_b32 s65, 0xaaa00000
    v_cndmask_b32 v105, v10, 0, s[64:65]
    s_mov_b32 s64, 0x00000000
    s_mov_b32 s65, 0x0000000a
    v_cndmask_b32 v121, v10, 0, s[64:65]
    s_mov_b32 s64, 0x55540000
    s_mov_b32 s65, 0x55400000
    v_cndmask_b32 v106, v10, 0, s[64:65]
    s_mov_b32 s64, 0x00000001
    s_mov_b32 s65, 0x00000015
    v_cndmask_b32 v122, v10, 0, s[64:65]
    s_mov_b32 s64, 0xaaa80000
    s_mov_b32 s65, 0xaa800000
    v_cndmask_b32 v107, v10, 0, s[64:65]
    s_mov_b32 s64, 0x00000002
    s_mov_b32 s65, 0x0000002a
    v_cndmask_b32 v123, v10, 0, s[64:65]
    s_mov_b32 s64, 0x55000000
    s_mov_b32 s65, 0x50000000
    v_cndmask_b32 v108, v10, 0, s[64:65]
    s_mov_b32 s64, 0x00000055
    s_mov_b32 s65, 0x00000555
    v_cndmask_b32 v124, v10, 0, s[64:65]
    s_mov_b32 s64, 0xaa000000
    s_mov_b32 s65, 0xa0000000
    v_cndmask_b32 v109, v10, 0, s[64:65]
    s_mov_b32 s64, 0x000000aa
    s_mov_b32 s65, 0x00000aaa
    v_cndmask_b32 v125, v10, 0, s[64:65]
    s_mov_b32 s64, 0x54000000
    s_mov_b32 s65, 0x40000000
    v_cndmask_b32 v110, v10, 0, s[64:65]
    s_mov_b32 s64, 0x00000155
    s_mov_b32 s65, 0x00001555
    v_cndmask_b32 v126, v10, 0, s[64:65]
    s_mov_b32 s64, 0xa8000000
    s_mov_b32 s65, 0x80000000
    v_cndmask_b32 v111, v10, 0, s[64:65]
    s_mov_b32 s64, 0x000002aa
    s_mov_b32 s65, 0x00002aaa
    v_cndmask_b32 v127, v10, 0, s[64:65]
    s_or_b32 s62, s30, s50
    s_cmp_lg_u32 s62, 0
    s_cbranch_scc1 L_c2_2
    v_mov_b32 v112, v10
    v_mov_b32 v113, v10
    v_mov_b32 v114, v10
    v_mov_b32 v115, v10
    v_mov_b32 v116, v10
    v_mov_b32 v117, v10
    v_mov_b32 v118, v10
    v_mov_b32 v119, v10
    v_mov_b32 v120, v10
    v_mov_b32 v121, v10
    v_mov_b32 v122, v10
    v_mov_b32 v123, v10
    v_mov_b32 v124, v10
    v_mov_b32 v125, v10
    v_mov_b32 v126, v10
    v_mov_b32 v127, v10
L_c2_2:
    s_waitcnt vmcnt(8)
    s_waitcnt lgkmcnt(0)
    ds_add_u32 v245, v247 offset:0
    ds_read_b128 v[160:163], v64 offset:0
    ds_read_b128 v[164:167], v65 offset:0
    ds_read_b128 v[168:171], v66 offset:0
    ds_read_b128 v[172:175], v67 offset:0
    s_add_u32 m0, s57, 131072
    s_add_u32 s54, s54, 128
    buffer_load_dwordx4 v16, s[4:7], s54 offen lds
    buffer_load_dwordx4 v17, s[4:7], s54 offen offset:1024 lds
    buffer_load_dwordx4 v18, s[4:7], s54 offen offset:2048 lds
    buffer_load_dwordx4 v19, s[4:7], s54 offen offset:3072 lds
    s_add_u32 m0, s57, 147456
    s_add_u32 s56, s56, 172032
    buffer_load_dwordx4 v20, s[8:11], s56 offen lds
    buffer_load_dwordx4 v21, s[8:11], s56 offen offset:1024 lds
    buffer_load_dwordx4 v22, s[8:11], s56 offen offset:2048 lds
    buffer_load_dwordx4 v23, s[8:11], s56 offen offset:3072 lds
    s_waitcnt vmcnt(8)
    s_waitcnt lgkmcnt(0)
    ds_add_u32 v245, v247 offset:0
    ds_read_b32 v246, v244 offset:512
    ds_read_b128 v[176:179], v64 offset:32768
    ds_read_b128 v[180:183], v65 offset:32768
    ds_read_b128 v[184:187], v66 offset:32768
    ds_read_b128 v[188:191], v67 offset:32768
    s_waitcnt lgkmcnt(4)
    s_mov_b32 s35, 4286578688
L_cl_3:
    v_cmp_gt_u32 vcc, 1, v246
    s_cbranch_vccz L_cok_4
    ds_read_b32 v246, v244 offset:512
    s_add_u32 s35, s35, 1
    s_waitcnt lgkmcnt(0)
    s_cbranch_scc0 L_cl_3
L_cok_4:
    s_add_u32 m0, s57, 0
    s_add_u32 s54, s54, 128
    buffer_load_dwordx4 v16, s[4:7], s54 offen lds
    buffer_load_dwordx4 v17, s[4:7], s54 offen offset:1024 lds
    buffer_load_dwordx4 v18, s[4:7], s54 offen offset:2048 lds
    buffer_load_dwordx4 v19, s[4:7], s54 offen offset:3072 lds
    s_add_u32 m0, s57, 16384
    s_add_u32 s56, s56, 172032
    buffer_load_dwordx4 v20, s[8:11], s56 offen lds
    buffer_load_dwordx4 v21, s[8:11], s56 offen offset:1024 lds
    buffer_load_dwordx4 v22, s[8:11], s56 offen offset:2048 lds
    buffer_load_dwordx4 v23, s[8:11], s56 offen offset:3072 lds
    s_waitcnt vmcnt(8)
    s_waitcnt lgkmcnt(0)
    ds_add_u32 v245, v247 offset:0
    ds_read_b32 v246, v244 offset:512
    ds_read_b128 v[192:195], v68 offset:0
    ds_read_b128 v[196:199], v69 offset:0
    ds_read_b128 v[200:203], v70 offset:0
    ds_read_b128 v[204:207], v71 offset:0
    s_waitcnt lgkmcnt(4)
    s_mov_b32 s35, 4286578688
L_cl_5:
    v_cmp_gt_u32 vcc, 2, v246
    s_cbranch_vccz L_cok_6
    ds_read_b32 v246, v244 offset:512
    s_add_u32 s35, s35, 1
    s_waitcnt lgkmcnt(0)
    s_cbranch_scc0 L_cl_5
L_cok_6:
    s_add_u32 m0, s57, 32768
    s_add_u32 s54, s54, 128
    buffer_load_dwordx4 v16, s[4:7], s54 offen lds
    buffer_load_dwordx4 v17, s[4:7], s54 offen offset:1024 lds
    buffer_load_dwordx4 v18, s[4:7], s54 offen offset:2048 lds
    buffer_load_dwordx4 v19, s[4:7], s54 offen offset:3072 lds
    s_add_u32 m0, s57, 49152
    s_add_u32 s56, s56, 172032
    buffer_load_dwordx4 v20, s[8:11], s56 offen lds
    buffer_load_dwordx4 v21, s[8:11], s56 offen offset:1024 lds
    buffer_load_dwordx4 v22, s[8:11], s56 offen offset:2048 lds
    buffer_load_dwordx4 v23, s[8:11], s56 offen offset:3072 lds
    s_waitcnt vmcnt(8)
    s_waitcnt lgkmcnt(0)
    ds_add_u32 v245, v247 offset:0
    ds_read_b32 v246, v244 offset:512
    ds_read_b128 v[208:211], v4 offset:0
    ds_read_b128 v[212:215], v5 offset:0
    ds_read_b128 v[216:219], v6 offset:0
    ds_read_b128 v[220:223], v7 offset:0
    s_waitcnt lgkmcnt(4)
    s_mov_b32 s35, 4286578688
L_cl_7:
    v_cmp_gt_u32 vcc, 3, v246
    s_cbranch_vccz L_cok_8
    ds_read_b32 v246, v244 offset:512
    s_add_u32 s35, s35, 1
    s_waitcnt lgkmcnt(0)
    s_cbranch_scc0 L_cl_7
L_cok_8:
    s_add_u32 m0, s58, 65536
    s_nop 0
    buffer_load_dwordx4 v24, s[8:11], s53 offen lds
    buffer_load_dwordx4 v25, s[8:11], s53 offen offset:1024 lds
    s_add_u32 m0, s58, 73728
    s_add_u32 s53, s53, 172032
    buffer_load_dwordx4 v24, s[8:11], s53 offen lds
    buffer_load_dwordx4 v25, s[8:11], s53 offen offset:1024 lds
    s_add_u32 m0, s58, 81920
    s_add_u32 s53, s53, 172032
    buffer_load_dwordx4 v24, s[8:11], s53 offen lds
    buffer_load_dwordx4 v25, s[8:11], s53 offen offset:1024 lds
    s_add_u32 m0, s58, 90112
    s_add_u32 s53, s53, 172032
    buffer_load_dwordx4 v24, s[8:11], s53 offen lds
    s_mov_b64 exec, s[38:39]
    buffer_load_dwordx4 v25, s[8:11], s53 offen offset:1024 lds
    s_mov_b64 exec, -1
    s_waitcnt vmcnt(8)
    s_waitcnt lgkmcnt(0)
    ds_add_u32 v245, v247 offset:0
    ds_read_b32 v246, v244 offset:512
    ds_read_b128 v[224:227], v4 offset:32768
    ds_read_b128 v[228:231], v5 offset:32768
    ds_read_b128 v[232:235], v6 offset:32768
    ds_read_b128 v[236:239], v7 offset:32768
    s_waitcnt lgkmcnt(4)
    s_mov_b32 s35, 4286578688
L_cl_9:
    v_cmp_gt_u32 vcc, 4, v246
    s_cbranch_vccz L_cok_10
    ds_read_b32 v246, v244 offset:512
    s_add_u32 s35, s35, 1
    s_waitcnt lgkmcnt(0)
    s_cbranch_scc0 L_cl_9
L_cok_10:
    s_add_u32 m0, s58, 98304
    s_add_u32 s53, s53, 172032
    buffer_load_dwordx4 v24, s[8:11], s53 offen lds
    buffer_load_dwordx4 v25, s[8:11], s53 offen offset:1024 lds
    s_add_u32 m0, s58, 106496
    s_add_u32 s53, s53, 172032
    buffer_load_dwordx4 v24, s[8:11], s53 offen lds
    buffer_load_dwordx4 v25, s[8:11], s53 offen offset:1024 lds
    s_add_u32 m0, s58, 114688
    s_add_u32 s53, s53, 172032
    buffer_load_dwordx4 v24, s[8:11], s53 offen lds
    buffer_load_dwordx4 v25, s[8:11], s53 offen offset:1024 lds
    s_waitcnt vmcnt(6)
    s_waitcnt lgkmcnt(0)
    ds_add_u32 v245, v247 offset:0
    ds_add_u32 v250, v247 offset:956
    buffer_load_dwordx2 v[240:241], v15, s[24:27], 0 offen sc1
    s_mov_b32 s35, 0
L_spin_11:
    ds_read_b32 v246, v244 offset:0
    s_add_u32 s35, s35, 1
    s_waitcnt lgkmcnt(0)
    v_cmp_gt_u32 vcc, 8, v246
    s_cmp_gt_u32 s35, 8388608
    s_cbranch_scc1 L_spok_12
    s_cbranch_vccnz L_spin_11
L_spok_12:
    ds_read_b64_tr_b16 v[64:65], v8 offset:0
    ds_read_b64_tr_b16 v[66:67], v8 offset:512
    ds_read_b64_tr_b16 v[68:69], v3 offset:0
    ds_read_b64_tr_b16 v[70:71], v3 offset:512
    ds_read_b64_tr_b16 v[72:73], v8 offset:2048
    ds_read_b64_tr_b16 v[74:75], v8 offset:2560
    ds_read_b64_tr_b16 v[76:77], v3 offset:2048
    ds_read_b64_tr_b16 v[78:79], v3 offset:2560
    s_waitcnt lgkmcnt(6)
    v_mfma_f32_32x32x16_bf16 v[32:47], v[64:67], v[128:131], 0
    ds_read_b64_tr_b16 v[80:81], v8 offset:4096
    ds_read_b64_tr_b16 v[82:83], v8 offset:4608
    s_waitcnt lgkmcnt(6)
    v_mfma_f32_32x32x16_bf16 v[48:63], v[68:71], v[128:131], 0
    ds_read_b64_tr_b16 v[84:85], v3 offset:4096
    ds_read_b64_tr_b16 v[86:87], v3 offset:4608
    s_waitcnt lgkmcnt(6)
    v_mfma_f32_32x32x16_bf16 v[32:47], v[72:75], v[132:135], v[32:47]
    ds_read_b64_tr_b16 v[64:65], v8 offset:6144
    ds_read_b64_tr_b16 v[66:67], v8 offset:6656
    s_waitcnt lgkmcnt(6)
    v_mfma_f32_32x32x16_bf16 v[48:63], v[76:79], v[132:135], v[48:63]
    ds_read_b64_tr_b16 v[68:69], v3 offset:6144
    ds_read_b64_tr_b16 v[70:71], v3 offset:6656
    s_waitcnt lgkmcnt(6)
    v_mfma_f32_32x32x16_bf16 v[32:47], v[80:83], v[136:139], v[32:47]
    ds_read_b64_tr_b16 v[72:73], v8 offset:8192
    ds_read_b64_tr_b16 v[74:75], v8 offset:8704
    s_waitcnt lgkmcnt(6)
    v_mfma_f32_32x32x16_bf16 v[48:63], v[84:87], v[136:139], v[48:63]
    ds_read_b64_tr_b16 v[76:77], v3 offset:8192
    ds_read_b64_tr_b16 v[78:79], v3 offset:8704
    s_waitcnt lgkmcnt(6)
    v_mfma_f32_32x32x16_bf16 v[32:47], v[64:67], v[140:143], v[32:47]
    ds_read_b64_tr_b16 v[80:81], v8 offset:10240
    ds_read_b64_tr_b16 v[82:83], v8 offset:10752
    s_waitcnt lgkmcnt(6)
    v_mfma_f32_32x32x16_bf16 v[48:63], v[68:71], v[140:143], v[48:63]
    ds_read_b64_tr_b16 v[84:85], v3 offset:10240
    ds_read_b64_tr_b16 v[86:87], v3 offset:10752
    s_waitcnt lgkmcnt(6)
    v_mfma_f32_32x32x16_bf16 v[32:47], v[72:75], v[144:147], v[32:47]
    ds_read_b64_tr_b16 v[64:65], v8 offset:12288
    ds_read_b64_tr_b16 v[66:67], v8 offset:12800
    s_waitcnt lgkmcnt(6)
    v_mfma_f32_32x32x16_bf16 v[48:63], v[76:79], v[144:147], v[48:63]
    ds_read_b64_tr_b16 v[68:69], v3 offset:12288
    ds_read_b64_tr_b16 v[70:71], v3 offset:12800
    s_waitcnt lgkmcnt(6)
    v_mfma_f32_32x32x16_bf16 v[32:47], v[80:83], v[148:151], v[32:47]
    ds_read_b64_tr_b16 v[72:73], v8 offset:14336
    ds_read_b64_tr_b16 v[74:75], v8 offset:14848
    s_waitcnt lgkmcnt(6)
    v_mfma_f32_32x32x16_bf16 v[48:63], v[84:87], v[148:151], v[48:63]
    ds_read_b64_tr_b16 v[76:77], v3 offset:14336
    ds_read_b64_tr_b16 v[78:79], v3 offset:14848
    s_waitcnt lgkmcnt(6)
    v_mfma_f32_32x32x16_bf16 v[32:47], v[64:67], v[152:155], v[32:47]
    ds_read_b64_tr_b16 v[80:81], v8 offset:16384
    ds_read_b64_tr_b16 v[82:83], v8 offset:16896
    s_waitcnt lgkmcnt(6)
    v_mfma_f32_32x32x16_bf16 v[48:63], v[68:71], v[152:155], v[48:63]
    ds_read_b64_tr_b16 v[84:85], v3 offset:16384
    ds_read_b64_tr_b16 v[86:87], v3 offset:16896
    s_waitcnt lgkmcnt(6)
    v_mfma_f32_32x32x16_bf16 v[32:47], v[72:75], v[156:159], v[32:47]
    ds_read_b64_tr_b16 v[64:65], v8 offset:18432
    ds_read_b64_tr_b16 v[66:67], v8 offset:18944
    s_waitcnt lgkmcnt(6)
    v_mfma_f32_32x32x16_bf16 v[48:63], v[76:79], v[156:159], v[48:63]
    ds_read_b64_tr_b16 v[68:69], v3 offset:18432
    ds_read_b64_tr_b16 v[70:71], v3 offset:18944
    s_waitcnt lgkmcnt(6)
    v_mfma_f32_32x32x16_bf16 v[32:47], v[80:83], v[160:163], v[32:47]
    ds_read_b64_tr_b16 v[72:73], v8 offset:20480
    ds_read_b64_tr_b16 v[74:75], v8 offset:20992
    s_waitcnt lgkmcnt(6)
    v_mfma_f32_32x32x16_bf16 v[48:63], v[84:87], v[160:163], v[48:63]
    ds_read_b64_tr_b16 v[76:77], v3 offset:20480
    ds_read_b64_tr_b16 v[78:79], v3 offset:20992
    s_waitcnt lgkmcnt(6)
    v_mfma_f32_32x32x16_bf16 v[32:47], v[64:67], v[164:167], v[32:47]
    ds_read_b64_tr_b16 v[80:81], v8 offset:22528
    ds_read_b64_tr_b16 v[82:83], v8 offset:23040
    s_waitcnt lgkmcnt(6)
    v_mfma_f32_32x32x16_bf16 v[48:63], v[68:71], v[164:167], v[48:63]
    ds_read_b64_tr_b16 v[84:85], v3 offset:22528
    ds_read_b64_tr_b16 v[86:87], v3 offset:23040
    s_waitcnt vmcnt(1)
    ds_add_u32 v245, v247 offset:0
    s_waitcnt lgkmcnt(7)
    v_mfma_f32_32x32x16_bf16 v[32:47], v[72:75], v[168:171], v[32:47]
    ds_read_b64_tr_b16 v[64:65], v8 offset:24576
    ds_read_b64_tr_b16 v[66:67], v8 offset:25088
    s_waitcnt lgkmcnt(7)
    v_mfma_f32_32x32x16_bf16 v[48:63], v[76:79], v[168:171], v[48:63]
    ds_read_b64_tr_b16 v[68:69], v3 offset:24576
    ds_read_b64_tr_b16 v[70:71], v3 offset:25088
    s_waitcnt lgkmcnt(7)
    v_mfma_f32_32x32x16_bf16 v[32:47], v[80:83], v[172:175], v[32:47]
    ds_read_b64_tr_b16 v[72:73], v8 offset:26624
    ds_read_b64_tr_b16 v[74:75], v8 offset:27136
    s_waitcnt lgkmcnt(7)
    v_mfma_f32_32x32x16_bf16 v[48:63], v[84:87], v[172:175], v[48:63]
    ds_read_b64_tr_b16 v[76:77], v3 offset:26624
    ds_read_b64_tr_b16 v[78:79], v3 offset:27136
    s_waitcnt lgkmcnt(6)
    v_mfma_f32_32x32x16_bf16 v[32:47], v[64:67], v[176:179], v[32:47]
    ds_read_b64_tr_b16 v[80:81], v8 offset:28672
    ds_read_b64_tr_b16 v[82:83], v8 offset:29184
    s_waitcnt lgkmcnt(6)
    v_mfma_f32_32x32x16_bf16 v[48:63], v[68:71], v[176:179], v[48:63]
    ds_read_b64_tr_b16 v[84:85], v3 offset:28672
    ds_read_b64_tr_b16 v[86:87], v3 offset:29184
    s_waitcnt lgkmcnt(6)
    v_mfma_f32_32x32x16_bf16 v[32:47], v[72:75], v[180:183], v[32:47]
    ds_read_b32 v246, v244
    ds_read_b64_tr_b16 v[64:65], v8 offset:30720
    ds_read_b64_tr_b16 v[66:67], v8 offset:31232
    s_waitcnt lgkmcnt(7)
    v_mfma_f32_32x32x16_bf16 v[48:63], v[76:79], v[180:183], v[48:63]
    ds_read_b64_tr_b16 v[68:69], v3 offset:30720
    ds_read_b64_tr_b16 v[70:71], v3 offset:31232
    s_waitcnt lgkmcnt(7)
    v_mfma_f32_32x32x16_bf16 v[32:47], v[80:83], v[184:187], v[32:47]
    s_waitcnt lgkmcnt(4)
    s_mov_b32 s35, 4286578688
L_cl_13:
    v_cmp_gt_u32 vcc, 9, v246
    s_cbranch_vccz L_cok_14
    ds_read_b32 v246, v244 offset:0
    s_add_u32 s35, s35, 1
    s_waitcnt lgkmcnt(0)
    s_cbranch_scc0 L_cl_13
L_cok_14:
    ds_read_b64_tr_b16 v[72:73], v8 offset:32768
    ds_read_b64_tr_b16 v[74:75], v8 offset:33280
    v_mfma_f32_32x32x16_bf16 v[48:63], v[84:87], v[184:187], v[48:63]
    ds_read_b64_tr_b16 v[76:77], v3 offset:32768
    ds_read_b64_tr_b16 v[78:79], v3 offset:33280
    s_waitcnt lgkmcnt(6)
    v_mfma_f32_32x32x16_bf16 v[32:47], v[64:67], v[188:191], v[32:47]
    ds_read_b64_tr_b16 v[80:81], v8 offset:34816
    ds_read_b64_tr_b16 v[82:83], v8 offset:35328
    s_waitcnt lgkmcnt(6)
    v_mfma_f32_32x32x16_bf16 v[48:63], v[68:71], v[188:191], v[48:63]
    ds_read_b64_tr_b16 v[84:85], v3 offset:34816
    ds_read_b64_tr_b16 v[86:87], v3 offset:35328
    s_waitcnt lgkmcnt(6)
    v_mfma_f32_32x32x16_bf16 v[32:47], v[72:75], v[192:195], v[32:47]
    ds_read_b64_tr_b16 v[64:65], v8 offset:36864
    ds_read_b64_tr_b16 v[66:67], v8 offset:37376
    s_lshl_b32 s62, s51, 14
    s_lshl_b32 s63, s50, 12
    s_waitcnt lgkmcnt(6)
    v_mfma_f32_32x32x16_bf16 v[48:63], v[76:79], v[192:195], v[48:63]
    ds_read_b64_tr_b16 v[68:69], v3 offset:36864
    ds_read_b64_tr_b16 v[70:71], v3 offset:37376
    s_add_u32 s62, s62, s63
    s_add_u32 s62, s62, 131072
    v_add_u32 v176, s62, v9
    s_waitcnt lgkmcnt(6)
    v_mfma_f32_32x32x16_bf16 v[32:47], v[80:83], v[196:199], v[32:47]
    ds_read_b64_tr_b16 v[72:73], v8 offset:38912
    ds_read_b64_tr_b16 v[74:75], v8 offset:39424
    s_mov_b32 s63, 0xfffeb000
    s_cmp_eq_u32 s50, 0
    s_cselect_b32 s62, s63, 0xfffff000
    v_add_u32 v177, s62, v176
    s_waitcnt lgkmcnt(6)
    v_mfma_f32_32x32x16_bf16 v[48:63], v[84:87], v[196:199], v[48:63]
    ds_read_b64_tr_b16 v[76:77], v3 offset:38912
    ds_read_b64_tr_b16 v[78:79], v3 offset:39424
    v_lshrrev_b32 v10, 4, v1
    v_lshlrev_b32 v11, 2, v10
    s_waitcnt lgkmcnt(6)
    v_mfma_f32_32x32x16_bf16 v[32:47], v[64:67], v[200:203], v[32:47]
    ds_read_b64_tr_b16 v[80:81], v8 offset:40960
    ds_read_b64_tr_b16 v[82:83], v8 offset:41472
    v_and_b32 v12, 15, v1
    v_xor_b32 v11, v11, v12
    s_waitcnt lgkmcnt(6)
    v_mfma_f32_32x32x16_bf16 v[48:63], v[68:71], v[200:203], v[48:63]
    ds_read_b64_tr_b16 v[84:85], v3 offset:40960
    ds_read_b64_tr_b16 v[86:87], v3 offset:41472
    v_mul_u32_u24 v248, 896, v10
    v_lshl_add_u32 v248, v11, 4, v248
    s_waitcnt lgkmcnt(6)
    v_mfma_f32_32x32x16_bf16 v[32:47], v[72:75], v[204:207], v[32:47]
    ds_read_b64_tr_b16 v[64:65], v8 offset:43008
    ds_read_b64_tr_b16 v[66:67], v8 offset:43520
    s_cmp_eq_u32 s32, 3
    s_cselect_b32 s62, 8, 64
    v_mov_b32 v12, 0x7ff00000
    s_waitcnt lgkmcnt(6)
    v_mfma_f32_32x32x16_bf16 v[48:63], v[76:79], v[204:207], v[48:63]
    ds_read_b64_tr_b16 v[68:69], v3 offset:43008
    ds_read_b64_tr_b16 v[70:71], v3 offset:43520
    v_cmp_le_u32 vcc, s62, v11
    s_lshl_b32 s63, s51, 7
    v_add_u32 v251, s63, v249
    v_cndmask_b32 v248, v248, v12, vcc
    s_waitcnt lgkmcnt(6)
    v_mfma_f32_32x32x16_bf16 v[32:47], v[80:83], v[208:211], v[32:47]
    ds_read_b64_tr_b16 v[72:73], v8 offset:45056
    ds_read_b64_tr_b16 v[74:75], v8 offset:45568
    s_waitcnt lgkmcnt(6)
    v_mfma_f32_32x32x16_bf16 v[48:63], v[84:87], v[208:211], v[48:63]
    ds_read_b64_tr_b16 v[76:77], v3 offset:45056
    ds_read_b64_tr_b16 v[78:79], v3 offset:45568
    s_waitcnt lgkmcnt(6)
    v_mfma_f32_32x32x16_bf16 v[32:47], v[64:67], v[212:215], v[32:47]
    ds_read_b64_tr_b16 v[80:81], v8 offset:47104
    ds_read_b64_tr_b16 v[82:83], v8 offset:47616
    s_waitcnt lgkmcnt(6)
    v_mfma_f32_32x32x16_bf16 v[48:63], v[68:71], v[212:215], v[48:63]
    ds_read_b64_tr_b16 v[84:85], v3 offset:47104
    ds_read_b64_tr_b16 v[86:87], v3 offset:47616
    s_waitcnt lgkmcnt(6)
    v_mfma_f32_32x32x16_bf16 v[32:47], v[72:75], v[216:219], v[32:47]
    ds_read_b64_tr_b16 v[64:65], v8 offset:49152
    ds_read_b64_tr_b16 v[66:67], v8 offset:49664
    s_waitcnt lgkmcnt(6)
    v_mfma_f32_32x32x16_bf16 v[48:63], v[76:79], v[216:219], v[48:63]
    ds_read_b64_tr_b16 v[68:69], v3 offset:49152
    ds_read_b64_tr_b16 v[70:71], v3 offset:49664
    s_waitcnt lgkmcnt(6)
    v_mfma_f32_32x32x16_bf16 v[32:47], v[80:83], v[220:223], v[32:47]
    ds_read_b64_tr_b16 v[72:73], v8 offset:51200
    ds_read_b64_tr_b16 v[74:75], v8 offset:51712
    s_waitcnt lgkmcnt(6)
    v_mfma_f32_32x32x16_bf16 v[48:63], v[84:87], v[220:223], v[48:63]
    ds_read_b64_tr_b16 v[76:77], v3 offset:51200
    ds_read_b64_tr_b16 v[78:79], v3 offset:51712
    s_waitcnt lgkmcnt(6)
    v_mfma_f32_32x32x16_bf16 v[32:47], v[64:67], v[224:227], v[32:47]
    ds_read_b64_tr_b16 v[80:81], v8 offset:53248
    ds_read_b64_tr_b16 v[82:83], v8 offset:53760
    s_waitcnt lgkmcnt(6)
    v_mfma_f32_32x32x16_bf16 v[48:63], v[68:71], v[224:227], v[48:63]
    ds_read_b64_tr_b16 v[84:85], v3 offset:53248
    ds_read_b64_tr_b16 v[86:87], v3 offset:53760
    s_waitcnt lgkmcnt(6)
    v_mfma_f32_32x32x16_bf16 v[32:47], v[72:75], v[228:231], v[32:47]
    ds_read_b64_tr_b16 v[64:65], v8 offset:55296
    ds_read_b64_tr_b16 v[66:67], v8 offset:55808
    s_waitcnt lgkmcnt(6)
    v_mfma_f32_32x32x16_bf16 v[48:63], v[76:79], v[228:231], v[48:63]
    ds_read_b64_tr_b16 v[68:69], v3 offset:55296
    ds_read_b64_tr_b16 v[70:71], v3 offset:55808
    s_waitcnt lgkmcnt(6)
    v_mfma_f32_32x32x16_bf16 v[32:47], v[80:83], v[232:235], v[32:47]
    s_waitcnt lgkmcnt(4)
    v_mfma_f32_32x32x16_bf16 v[48:63], v[84:87], v[232:235], v[48:63]
    s_waitcnt lgkmcnt(2)
    v_mfma_f32_32x32x16_bf16 v[32:47], v[64:67], v[236:239], v[32:47]
    s_waitcnt lgkmcnt(0)
    v_mfma_f32_32x32x16_bf16 v[48:63], v[68:71], v[236:239], v[48:63]
    v_mov_b32 v11, s66
    v_cndmask_b32 v12, v11, 0, s[68:69]
    s_lshl_b32 s62, s55, 11
    s_add_u32 s62, s62, 122880
    v_add_u32 v10, s62, v9
    s_nop 5
    v_cvt_pk_bf16_f32 v33, v32, v33
    v_lshlrev_b32 v32, 16, v33
    v_and_b32 v33, 0xffff0000, v33
    v_cvt_pk_bf16_f32 v35, v34, v35
    v_lshlrev_b32 v34, 16, v35
    v_and_b32 v35, 0xffff0000, v35
    v_cvt_pk_bf16_f32 v37, v36, v37
    v_lshlrev_b32 v36, 16, v37
    v_and_b32 v37, 0xffff0000, v37
    v_cvt_pk_bf16_f32 v39, v38, v39
    v_lshlrev_b32 v38, 16, v39
    v_and_b32 v39, 0xffff0000, v39
    v_cvt_pk_bf16_f32 v41, v40, v41
    v_lshlrev_b32 v40, 16, v41
    v_and_b32 v41, 0xffff0000, v41
    v_cvt_pk_bf16_f32 v43, v42, v43
    v_lshlrev_b32 v42, 16, v43
    v_and_b32 v43, 0xffff0000, v43
    v_cvt_pk_bf16_f32 v45, v44, v45
    v_lshlrev_b32 v44, 16, v45
    v_and_b32 v45, 0xffff0000, v45
    v_cvt_pk_bf16_f32 v47, v46, v47
    v_lshlrev_b32 v46, 16, v47
    v_and_b32 v47, 0xffff0000, v47
    v_mul_f32 v32, v11, v32
    v_mul_f32 v33, v11, v33
    v_mul_f32 v34, v11, v34
    v_mul_f32 v35, v11, v35
    v_mul_f32 v36, v11, v36
    v_mul_f32 v37, v11, v37
    v_mul_f32 v38, v11, v38
    v_mul_f32 v39, v11, v39
    v_mul_f32 v40, v11, v40
    v_mul_f32 v41, v11, v41
    v_mul_f32 v42, v11, v42
    v_mul_f32 v43, v11, v43
    v_mul_f32 v44, v12, v44
    v_mul_f32 v45, v12, v45
    v_mul_f32 v46, v12, v46
    v_mul_f32 v47, v12, v47
    v_cvt_pk_bf16_f32 v32, v32, v33
    v_cvt_pk_bf16_f32 v33, v34, v35
    v_cvt_pk_bf16_f32 v34, v36, v37
    v_cvt_pk_bf16_f32 v35, v38, v39
    v_cvt_pk_bf16_f32 v36, v40, v41
    v_cvt_pk_bf16_f32 v37, v42, v43
    v_cvt_pk_bf16_f32 v38, v44, v45
    v_cvt_pk_bf16_f32 v39, v46, v47
    ds_write_b128 v10, v[32:35] offset:0
    ds_write_b128 v10, v[36:39] offset:1024
    s_waitcnt lgkmcnt(0)
    ds_add_u32 v250, v247 offset:764
    v_cvt_pk_bf16_f32 v49, v48, v49
    v_lshlrev_b32 v48, 16, v49
    v_and_b32 v49, 0xffff0000, v49
    v_cvt_pk_bf16_f32 v51, v50, v51
    v_lshlrev_b32 v50, 16, v51
    v_and_b32 v51, 0xffff0000, v51
    v_cvt_pk_bf16_f32 v53, v52, v53
    v_lshlrev_b32 v52, 16, v53
    v_and_b32 v53, 0xffff0000, v53
    v_cvt_pk_bf16_f32 v55, v54, v55
    v_lshlrev_b32 v54, 16, v55
    v_and_b32 v55, 0xffff0000, v55
    v_cvt_pk_bf16_f32 v57, v56, v57
    v_lshlrev_b32 v56, 16, v57
    v_and_b32 v57, 0xffff0000, v57
    v_cvt_pk_bf16_f32 v59, v58, v59
    v_lshlrev_b32 v58, 16, v59
    v_and_b32 v59, 0xffff0000, v59
    v_cvt_pk_bf16_f32 v61, v60, v61
    v_lshlrev_b32 v60, 16, v61
    v_and_b32 v61, 0xffff0000, v61
    v_cvt_pk_bf16_f32 v63, v62, v63
    v_lshlrev_b32 v62, 16, v63
    v_and_b32 v63, 0xffff0000, v63
    v_mul_f32 v48, v11, v48
    v_mul_f32 v49, v11, v49
    v_mul_f32 v50, v11, v50
    v_mul_f32 v51, v11, v51
    v_mul_f32 v52, v11, v52
    v_mul_f32 v53, v11, v53
    v_mul_f32 v54, v11, v54
    v_mul_f32 v55, v11, v55
    v_mul_f32 v56, v11, v56
    v_mul_f32 v57, v11, v57
    v_mul_f32 v58, v11, v58
    v_mul_f32 v59, v11, v59
    v_mul_f32 v60, v12, v60
    v_mul_f32 v61, v12, v61
    v_mul_f32 v62, v12, v62
    v_mul_f32 v63, v12, v63
    v_cvt_pk_bf16_f32 v16, v48, v49
    v_cvt_pk_bf16_f32 v17, v50, v51
    v_cvt_pk_bf16_f32 v18, v52, v53
    v_cvt_pk_bf16_f32 v19, v54, v55
    v_cvt_pk_bf16_f32 v20, v56, v57
    v_cvt_pk_bf16_f32 v21, v58, v59
    v_cvt_pk_bf16_f32 v22, v60, v61
    v_cvt_pk_bf16_f32 v23, v62, v63
    s_waitcnt vmcnt(0)
    s_mov_b32 s35, 0
L_nlp_15:
    v_readfirstlane_b32 s60, v240
    v_readfirstlane_b32 s61, v241
    s_add_u32 s35, s35, 1
    s_cmp_lg_u32 s60, 0
    s_cbranch_scc1 L_nok_16
    s_cmp_gt_u32 s35, 1048576
    s_cbranch_scc1 L_nok_16
    buffer_load_dwordx2 v[240:241], v15, s[24:27], 0 offen sc1
    s_waitcnt vmcnt(0)
    s_branch L_nlp_15
L_nok_16:
    s_and_b32 s62, s30, 3
    s_mul_i32 s62, s62, 100352
    s_lshl_b32 s63, s32, 8
    s_add_u32 s62, s62, s63
    s_and_b32 s63, s55, 1
    s_lshl_b32 s63, s63, 7
    s_add_u32 s62, s62, s63
    s_lshr_b32 s63, s55, 1
    s_mul_i32 s63, s63, 50176
    s_add_u32 s62, s62, s63
    v_mul_u32_u24 v10, 896, v1
    s_mov_b32 s64, 0xffffffff
    s_mov_b32 s65, 0x00ffffff
    s_mov_b64 exec, s[64:65]
    buffer_load_dword v255, v10, s[12:15], s62 offen
    s_mov_b64 exec, -1
    s_mov_b32 s35, 0
L_spin_17:
    ds_read_b32 v246, v249 offset:636
    s_add_u32 s35, s35, 1
    s_waitcnt lgkmcnt(0)
    v_cmp_gt_u32 vcc, 4, v246
    s_cmp_gt_u32 s35, 8388608
    s_cbranch_scc1 L_spok_18
    s_cbranch_vccnz L_spin_17
L_spok_18:
    s_branch L_xB
L_consB:
    s_mov_b32 s24, s46
    s_mov_b32 s25, s47
    s_mov_b32 s26, 256
    s_mov_b32 s27, 0x20000
    v_mov_b32 v15, 0
    v_lshlrev_b32 v9, 4, v1
    s_or_b32 s62, s2, s31
    s_cmp_lg_u32 s62, 0
    s_cbranch_scc1 L_non_19
    s_memrealtime s[60:61]
    s_waitcnt lgkmcnt(0)
    s_or_b32 s60, s60, 1
    v_mov_b32 v240, s60
    v_mov_b32 v241, s61
    s_mov_b64 exec, 1
    buffer_store_dwordx2 v[240:241], v15, s[24:27], 0 offen sc1
    s_mov_b64 exec, -1
L_non_19:
    s_mov_b32 s16, s32
    s_mov_b32 s17, s33
    s_mov_b32 s20, s34
    s_mov_b32 s21, s35
    s_mov_b32 s18, 0x1c0000
    s_mov_b32 s19, 0x20000
    s_mov_b32 s22, 0x126000
    s_mov_b32 s23, 0x20000
    s_bfe_u32 s62, s2, 0x40003
    s_lshl_b32 s62, s62, 8
    v_add_u32 v10, s62, v0
    v_and_b32 v11, 511, v10
    v_mul_u32_u24 v11, 896, v11
    v_lshrrev_b32 v12, 9, v10
    v_add_u32 v12, 2, v12
    v_cmp_gt_u32 vcc, 7, v12
    v_lshl_add_u32 v11, v12, 7, v11
    v_mov_b32 v12, 0x7ff00000
    v_cndmask_b32 v11, v12, v11, vcc
    s_bfe_u32 s62, s2, 0x20001
    s_mul_i32 s62, s62, 458752
    v_lshrrev_b32 v12, 2, v10
    buffer_load_dword v188, v11, s[16:19], s62 offen
    v_mul_u32_u24 v12, 896, v12
    v_and_b32 v10, 3, v10
    v_lshl_add_u32 v12, v10, 7, v12
    s_and_b32 s62, s2, 1
    s_mul_i32 s62, s62, 384
    s_add_u32 s62, s62, 344064
    buffer_load_dword v189, v12, s[20:23], s62 offen
    s_mov_b32 s16, s4
    s_mov_b32 s17, s5
    s_mov_b32 s20, s40
    s_mov_b32 s21, s41
    s_mov_b32 s18, 0x1c0000
    s_mov_b32 s19, 0x20000
    s_mov_b32 s22, 0x126000
    s_mov_b32 s23, 0x20000
    s_bfe_u32 s62, s2, 0x40003
    s_lshl_b32 s62, s62, 8
    v_add_u32 v10, s62, v0
    v_and_b32 v11, 511, v10
    v_mul_u32_u24 v11, 896, v11
    v_lshrrev_b32 v12, 9, v10
    v_add_u32 v12, 2, v12
    v_cmp_gt_u32 vcc, 7, v12
    v_lshl_add_u32 v11, v12, 7, v11
    v_mov_b32 v12, 0x7ff00000
    v_cndmask_b32 v11, v12, v11, vcc
    s_bfe_u32 s62, s2, 0x20001
    s_mul_i32 s62, s62, 458752
    v_lshrrev_b32 v12, 2, v10
    buffer_load_dword v190, v11, s[16:19], s62 offen
    v_mul_u32_u24 v12, 896, v12
    v_and_b32 v10, 3, v10
    v_lshl_add_u32 v12, v10, 7, v12
    s_and_b32 s62, s2, 1
    s_mul_i32 s62, s62, 384
    s_add_u32 s62, s62, 344064
    buffer_load_dword v191, v12, s[20:23], s62 offen
    s_and_b32 s64, s31, 1
    s_lshl_b32 s64, s64, 13
    v_and_b32 v10, 31, v1
    v_bfe_u32 v11, v1, 1, 3
    v_lshrrev_b32 v12, 5, v1
    v_xor_b32 v11, v11, v12
    v_lshlrev_b32 v10, 7, v10
    v_add_u32 v10, s64, v10
    v_lshl_add_u32 v4, v11, 4, v10
    v_xor_b32 v5, 32, v4
    v_xor_b32 v6, 64, v4
    v_xor_b32 v7, 96, v4
    s_lshr_b32 s65, s31, 1
    s_mul_i32 s63, s65, 56
    v_bfe_u32 v10, v1, 2, 2
    v_lshrrev_b32 v12, 5, v1
    v_lshl_add_u32 v11, v12, 3, v10
    v_lshlrev_b32 v11, 7, v11
    v_lshrrev_b32 v10, 1, v10
    v_lshlrev_b32 v10, 6, v10
    v_and_b32 v12, 3, v1
    v_lshlrev_b32 v12, 3, v12
    v_and_b32 v8, 16, v1
    v_lshl_add_u32 v12, v8, 1, v12
    v_add_u32 v12, s63, v12
    v_xor_b32 v12, v12, v10
    v_add_u32 v8, v11, v12
    v_add_u32 v16, 0x0, v4
    v_add_u32 v17, 0x0, v5
    v_add_u32 v18, 0x0, v6
    v_add_u32 v19, 0x0, v7
    v_add_u32 v20, 0x0, v8
    v_add_u32 v21, 0x10000, v4
    v_add_u32 v22, 0x10000, v5
    v_add_u32 v23, 0x10000, v6
    v_add_u32 v24, 0x10000, v7
    v_add_u32 v25, 0x10000, v8
    v_add_u32 v26, 0x20000, v4
    v_add_u32 v27, 0x20000, v5
    v_add_u32 v28, 0x20000, v6
    v_add_u32 v29, 0x20000, v7
    v_add_u32 v30, 0x20000, v8
    s_lshl_b32 s67, s31, 13
    s_add_u32 s62, s67, 131072
    v_add_u32 v2, s62, v9
    s_cmp_eq_u32 s28, 0
    s_cselect_b32 s12, s36, s42
    s_cselect_b32 s13, s37, s43
    s_mov_b32 s14, 0x62000
    s_mov_b32 s15, 0x20000
    s_mov_b32 s16, s48
    s_mov_b32 s17, s49
    s_mov_b32 s18, 0x2400000
    s_mov_b32 s19, 0x20000
    s_mov_b32 s20, s44
    s_mov_b32 s21, s45
    s_mov_b32 s22, 0x380000
    s_mov_b32 s23, 0x20000
    s_mov_b32 s68, 0
    s_mov_b32 s69, -1
    s_mov_b32 s66, 0x3e8b97f6
    s_lshl_b32 s52, s31, 10
    s_lshr_b32 s51, s31, 2
    s_sub_u32 s63, 3, s55
    s_cmp_lt_u32 s31, 4
    s_cselect_b32 s50, s63, s55
    s_lshl_b32 s59, s28, 3
    s_add_u32 s59, s59, s29
    s_lshl_b32 s59, s59, 4
    s_add_u32 s59, s59, s30
    s_mul_i32 s37, s59, 33280
    s_lshl_b32 s59, s59, 15
    s_and_b32 s32, s29, 3
    s_lshr_b32 s62, s29, 2
    s_lshl_b32 s33, s30, 1
    s_add_u32 s33, s33, s62
    s_mul_i32 s34, s31, 3584
    s_lshl_b32 s62, s32, 8
    s_add_u32 s34, s34, s62
    s_mov_b32 s35, 0
L_spin_20:
    ds_read_b32 v246, v244 offset:0
    s_add_u32 s35, s35, 1
    s_waitcnt lgkmcnt(0)
    v_cmp_gt_u32 vcc, 1, v246
    s_cmp_gt_u32 s35, 8388608
    s_cbranch_scc1 L_spok_21
    s_cbranch_vccnz L_spin_20
L_spok_21:
    ds_read_b128 v[128:131], v16 offset:0
    ds_read_b64_tr_b16 v[152:153], v20 offset:16384
    ds_read_b64_tr_b16 v[154:155], v20 offset:16896
    ds_read_b128 v[132:135], v16 offset:4096
    ds_read_b64_tr_b16 v[156:157], v20 offset:18432
    ds_read_b64_tr_b16 v[158:159], v20 offset:18944
    ds_read_b128 v[136:139], v17 offset:0
    ds_read_b64_tr_b16 v[160:161], v20 offset:20480
    ds_read_b64_tr_b16 v[162:163], v20 offset:20992
    ds_read_b128 v[140:143], v17 offset:4096
    ds_read_b64_tr_b16 v[164:165], v20 offset:22528
    ds_read_b64_tr_b16 v[166:167], v20 offset:23040
    s_waitcnt lgkmcnt(9)
    v_mfma_f32_32x32x16_bf16 v[32:47], v[152:155], v[128:131], 0
    ds_read_b128 v[144:147], v18 offset:0
    ds_read_b64_tr_b16 v[168:169], v20 offset:24576
    s_waitcnt lgkmcnt(10)
    v_mfma_f32_32x32x16_bf16 v[48:63], v[152:155], v[132:135], 0
    ds_read_b64_tr_b16 v[170:171], v20 offset:25088
    s_waitcnt lgkmcnt(9)
    v_mfma_f32_32x32x16_bf16 v[64:79], v[128:131], v[156:159], 0
    ds_read_b128 v[148:151], v18 offset:4096
    ds_read_b64_tr_b16 v[172:173], v20 offset:26624
    v_mfma_f32_32x32x16_bf16 v[80:95], v[132:135], v[156:159], 0
    ds_read_b64_tr_b16 v[174:175], v20 offset:27136
    s_waitcnt lgkmcnt(9)
    v_mfma_f32_32x32x16_bf16 v[32:47], v[160:163], v[136:139], v[32:47]
    ds_read_b128 v[128:131], v19 offset:0
    ds_read_b64_tr_b16 v[152:153], v20 offset:28672
    s_waitcnt lgkmcnt(10)
    v_mfma_f32_32x32x16_bf16 v[48:63], v[160:163], v[140:143], v[48:63]
    ds_read_b64_tr_b16 v[154:155], v20 offset:29184
    ds_read_b32 v246, v244
    s_waitcnt lgkmcnt(10)
    v_mfma_f32_32x32x16_bf16 v[64:79], v[136:139], v[164:167], v[64:79]
    ds_read_b128 v[132:135], v19 offset:4096
    ds_read_b64_tr_b16 v[156:157], v20 offset:30720
    v_mfma_f32_32x32x16_bf16 v[80:95], v[140:143], v[164:167], v[80:95]
    ds_read_b64_tr_b16 v[158:159], v20 offset:31232
    s_waitcnt lgkmcnt(10)
    v_mfma_f32_32x32x16_bf16 v[32:47], v[168:171], v[144:147], v[32:47]
    s_waitcnt lgkmcnt(3)
    s_mov_b32 s35, 4286578688
L_cl_22:
    v_cmp_gt_u32 vcc, 2, v246
    s_cbranch_vccz L_cok_23
    ds_read_b32 v246, v244 offset:0
    s_add_u32 s35, s35, 1
    s_waitcnt lgkmcnt(0)
    s_cbranch_scc0 L_cl_22
L_cok_23:
    ds_read_b128 v[136:139], v16 offset:32768
    ds_read_b64_tr_b16 v[160:161], v20 offset:49152
    v_mfma_f32_32x32x16_bf16 v[48:63], v[168:171], v[148:151], v[48:63]
    ds_read_b64_tr_b16 v[162:163], v20 offset:49664
    v_mfma_f32_32x32x16_bf16 v[64:79], v[144:147], v[172:175], v[64:79]
    ds_read_b128 v[140:143], v16 offset:36864
    ds_read_b64_tr_b16 v[164:165], v20 offset:51200
    v_mfma_f32_32x32x16_bf16 v[80:95], v[148:151], v[172:175], v[80:95]
    ds_read_b64_tr_b16 v[166:167], v20 offset:51712
    v_mfma_f32_32x32x16_bf16 v[32:47], v[152:155], v[128:131], v[32:47]
    ds_read_b128 v[144:147], v17 offset:32768
    ds_read_b64_tr_b16 v[168:169], v20 offset:53248
    s_waitcnt lgkmcnt(10)
    v_mfma_f32_32x32x16_bf16 v[48:63], v[152:155], v[132:135], v[48:63]
    ds_read_b64_tr_b16 v[170:171], v20 offset:53760
    s_waitcnt lgkmcnt(9)
    v_mfma_f32_32x32x16_bf16 v[64:79], v[128:131], v[156:159], v[64:79]
    ds_read_b128 v[148:151], v17 offset:36864
    ds_read_b64_tr_b16 v[172:173], v20 offset:55296
    v_mfma_f32_32x32x16_bf16 v[80:95], v[132:135], v[156:159], v[80:95]
    ds_read_b64_tr_b16 v[174:175], v20 offset:55808
    ds_add_u32 v245, v247 offset:0
    s_waitcnt lgkmcnt(10)
    v_mfma_f32_32x32x16_bf16 v[32:47], v[160:163], v[136:139], v[32:47]
    ds_read_b128 v[128:131], v18 offset:32768
    ds_read_b64_tr_b16 v[152:153], v20 offset:57344
    s_waitcnt lgkmcnt(11)
    v_mfma_f32_32x32x16_bf16 v[48:63], v[160:163], v[140:143], v[48:63]
    ds_read_b64_tr_b16 v[154:155], v20 offset:57856
    s_waitcnt lgkmcnt(10)
    v_mfma_f32_32x32x16_bf16 v[64:79], v[136:139], v[164:167], v[64:79]
    ds_read_b128 v[132:135], v18 offset:36864
    ds_read_b64_tr_b16 v[156:157], v20 offset:59392
    v_mfma_f32_32x32x16_bf16 v[80:95], v[140:143], v[164:167], v[80:95]
    ds_read_b64_tr_b16 v[158:159], v20 offset:59904
    s_waitcnt lgkmcnt(10)
    v_mfma_f32_32x32x16_bf16 v[32:47], v[168:171], v[144:147], v[32:47]
    ds_read_b128 v[136:139], v19 offset:32768
    ds_read_b64_tr_b16 v[160:161], v20 offset:61440
    s_waitcnt lgkmcnt(11)
    v_mfma_f32_32x32x16_bf16 v[48:63], v[168:171], v[148:151], v[48:63]
    ds_read_b64_tr_b16 v[162:163], v20 offset:61952
    ds_read_b32 v246, v244
    s_waitcnt lgkmcnt(11)
    v_mfma_f32_32x32x16_bf16 v[64:79], v[144:147], v[172:175], v[64:79]
    ds_read_b128 v[140:143], v19 offset:36864
    ds_read_b64_tr_b16 v[164:165], v20 offset:63488
    v_mfma_f32_32x32x16_bf16 v[80:95], v[148:151], v[172:175], v[80:95]
    ds_read_b64_tr_b16 v[166:167], v20 offset:64000
    s_waitcnt lgkmcnt(10)
    v_mfma_f32_32x32x16_bf16 v[32:47], v[152:155], v[128:131], v[32:47]
    s_waitcnt lgkmcnt(3)
    s_mov_b32 s35, 4286578688
L_cl_24:
    v_cmp_gt_u32 vcc, 3, v246
    s_cbranch_vccz L_cok_25
    ds_read_b32 v246, v244 offset:0
    s_add_u32 s35, s35, 1
    s_waitcnt lgkmcnt(0)
    s_cbranch_scc0 L_cl_24
L_cok_25:
    ds_read_b128 v[144:147], v21 offset:0
    ds_read_b64_tr_b16 v[168:169], v25 offset:16384
    v_mfma_f32_32x32x16_bf16 v[48:63], v[152:155], v[132:135], v[48:63]
    ds_read_b64_tr_b16 v[170:171], v25 offset:16896
    v_mfma_f32_32x32x16_bf16 v[64:79], v[128:131], v[156:159], v[64:79]
    ds_read_b128 v[148:151], v21 offset:4096
    ds_read_b64_tr_b16 v[172:173], v25 offset:18432
    v_mfma_f32_32x32x16_bf16 v[80:95], v[132:135], v[156:159], v[80:95]
    ds_read_b64_tr_b16 v[174:175], v25 offset:18944
    v_mfma_f32_32x32x16_bf16 v[32:47], v[160:163], v[136:139], v[32:47]
    ds_read_b128 v[128:131], v22 offset:0
    ds_read_b64_tr_b16 v[152:153], v25 offset:20480
    s_waitcnt lgkmcnt(10)
    v_mfma_f32_32x32x16_bf16 v[48:63], v[160:163], v[140:143], v[48:63]
    ds_read_b64_tr_b16 v[154:155], v25 offset:20992
    s_waitcnt lgkmcnt(9)
    v_mfma_f32_32x32x16_bf16 v[64:79], v[136:139], v[164:167], v[64:79]
    ds_read_b128 v[132:135], v22 offset:4096
    ds_read_b64_tr_b16 v[156:157], v25 offset:22528
    v_mfma_f32_32x32x16_bf16 v[80:95], v[140:143], v[164:167], v[80:95]
    ds_read_b64_tr_b16 v[158:159], v25 offset:23040
    ds_add_u32 v245, v247 offset:0
    s_waitcnt lgkmcnt(10)
    v_mfma_f32_32x32x16_bf16 v[32:47], v[168:171], v[144:147], v[32:47]
    ds_read_b128 v[136:139], v23 offset:0
    ds_read_b64_tr_b16 v[160:161], v25 offset:24576
    s_waitcnt lgkmcnt(11)
    v_mfma_f32_32x32x16_bf16 v[48:63], v[168:171], v[148:151], v[48:63]
    ds_read_b64_tr_b16 v[162:163], v25 offset:25088
    s_waitcnt lgkmcnt(10)
    v_mfma_f32_32x32x16_bf16 v[64:79], v[144:147], v[172:175], v[64:79]
    ds_read_b128 v[140:143], v23 offset:4096
    ds_read_b64_tr_b16 v[164:165], v25 offset:26624
    v_mfma_f32_32x32x16_bf16 v[80:95], v[148:151], v[172:175], v[80:95]
    ds_read_b64_tr_b16 v[166:167], v25 offset:27136
    s_waitcnt lgkmcnt(10)
    v_mfma_f32_32x32x16_bf16 v[32:47], v[152:155], v[128:131], v[32:47]
    ds_read_b128 v[144:147], v24 offset:0
    ds_read_b64_tr_b16 v[168:169], v25 offset:28672
    s_waitcnt lgkmcnt(11)
    v_mfma_f32_32x32x16_bf16 v[48:63], v[152:155], v[132:135], v[48:63]
    ds_read_b64_tr_b16 v[170:171], v25 offset:29184
    ds_read_b32 v246, v244
    s_waitcnt lgkmcnt(11)
    v_mfma_f32_32x32x16_bf16 v[64:79], v[128:131], v[156:159], v[64:79]
    ds_read_b128 v[148:151], v24 offset:4096
    ds_read_b64_tr_b16 v[172:173], v25 offset:30720
    v_mfma_f32_32x32x16_bf16 v[80:95], v[132:135], v[156:159], v[80:95]
    ds_read_b64_tr_b16 v[174:175], v25 offset:31232
    s_waitcnt lgkmcnt(10)
    v_mfma_f32_32x32x16_bf16 v[32:47], v[160:163], v[136:139], v[32:47]
    s_waitcnt lgkmcnt(3)
    s_mov_b32 s35, 4286578688
L_cl_26:
    v_cmp_gt_u32 vcc, 4, v246
    s_cbranch_vccz L_cok_27
    ds_read_b32 v246, v244 offset:0
    s_add_u32 s35, s35, 1
    s_waitcnt lgkmcnt(0)
    s_cbranch_scc0 L_cl_26
L_cok_27:
    ds_read_b128 v[128:131], v21 offset:32768
    ds_read_b64_tr_b16 v[152:153], v25 offset:49152
    v_mfma_f32_32x32x16_bf16 v[48:63], v[160:163], v[140:143], v[48:63]
    ds_read_b64_tr_b16 v[154:155], v25 offset:49664
    v_mfma_f32_32x32x16_bf16 v[64:79], v[136:139], v[164:167], v[64:79]
    ds_read_b128 v[132:135], v21 offset:36864
    ds_read_b64_tr_b16 v[156:157], v25 offset:51200
    v_mfma_f32_32x32x16_bf16 v[80:95], v[140:143], v[164:167], v[80:95]
    ds_read_b64_tr_b16 v[158:159], v25 offset:51712
    v_mfma_f32_32x32x16_bf16 v[32:47], v[168:171], v[144:147], v[32:47]
    ds_read_b128 v[136:139], v22 offset:32768
    ds_read_b64_tr_b16 v[160:161], v25 offset:53248
    s_waitcnt lgkmcnt(10)
    v_mfma_f32_32x32x16_bf16 v[48:63], v[168:171], v[148:151], v[48:63]
    ds_read_b64_tr_b16 v[162:163], v25 offset:53760
    s_waitcnt lgkmcnt(9)
    v_mfma_f32_32x32x16_bf16 v[64:79], v[144:147], v[172:175], v[64:79]
    ds_read_b128 v[140:143], v22 offset:36864
    ds_read_b64_tr_b16 v[164:165], v25 offset:55296
    v_mfma_f32_32x32x16_bf16 v[80:95], v[148:151], v[172:175], v[80:95]
    ds_read_b64_tr_b16 v[166:167], v25 offset:55808
    ds_add_u32 v245, v247 offset:0
    s_waitcnt lgkmcnt(10)
    v_mfma_f32_32x32x16_bf16 v[32:47], v[152:155], v[128:131], v[32:47]
    ds_read_b128 v[144:147], v23 offset:32768
    ds_read_b64_tr_b16 v[168:169], v25 offset:57344
    s_waitcnt lgkmcnt(11)
    v_mfma_f32_32x32x16_bf16 v[48:63], v[152:155], v[132:135], v[48:63]
    ds_read_b64_tr_b16 v[170:171], v25 offset:57856
    s_waitcnt lgkmcnt(10)
    v_mfma_f32_32x32x16_bf16 v[64:79], v[128:131], v[156:159], v[64:79]
    ds_read_b128 v[148:151], v23 offset:36864
    ds_read_b64_tr_b16 v[172:173], v25 offset:59392
    v_mfma_f32_32x32x16_bf16 v[80:95], v[132:135], v[156:159], v[80:95]
    ds_read_b64_tr_b16 v[174:175], v25 offset:59904
    s_waitcnt lgkmcnt(10)
    v_mfma_f32_32x32x16_bf16 v[32:47], v[160:163], v[136:139], v[32:47]
    ds_read_b128 v[128:131], v24 offset:32768
    ds_read_b64_tr_b16 v[152:153], v25 offset:61440
    s_waitcnt lgkmcnt(11)
    v_mfma_f32_32x32x16_bf16 v[48:63], v[160:163], v[140:143], v[48:63]
    ds_read_b64_tr_b16 v[154:155], v25 offset:61952
    ds_read_b32 v246, v244
    s_waitcnt lgkmcnt(11)
    v_mfma_f32_32x32x16_bf16 v[64:79], v[136:139], v[164:167], v[64:79]
    ds_read_b128 v[132:135], v24 offset:36864
    ds_read_b64_tr_b16 v[156:157], v25 offset:63488
    v_mfma_f32_32x32x16_bf16 v[80:95], v[140:143], v[164:167], v[80:95]
    ds_read_b64_tr_b16 v[158:159], v25 offset:64000
    s_waitcnt lgkmcnt(10)
    v_mfma_f32_32x32x16_bf16 v[32:47], v[168:171], v[144:147], v[32:47]
    s_waitcnt lgkmcnt(3)
    s_mov_b32 s35, 4286578688
L_cl_28:
    v_cmp_gt_u32 vcc, 5, v246
    s_cbranch_vccz L_cok_29
    ds_read_b32 v246, v244 offset:0
    s_add_u32 s35, s35, 1
    s_waitcnt lgkmcnt(0)
    s_cbranch_scc0 L_cl_28
L_cok_29:
    ds_read_b128 v[136:139], v26 offset:0
    ds_read_b64_tr_b16 v[160:161], v30 offset:16384
    v_mfma_f32_32x32x16_bf16 v[48:63], v[168:171], v[148:151], v[48:63]
    ds_read_b64_tr_b16 v[162:163], v30 offset:16896
    v_mfma_f32_32x32x16_bf16 v[64:79], v[144:147], v[172:175], v[64:79]
    ds_read_b128 v[140:143], v26 offset:4096
    ds_read_b64_tr_b16 v[164:165], v30 offset:18432
    v_mfma_f32_32x32x16_bf16 v[80:95], v[148:151], v[172:175], v[80:95]
    ds_read_b64_tr_b16 v[166:167], v30 offset:18944
    v_mfma_f32_32x32x16_bf16 v[32:47], v[152:155], v[128:131], v[32:47]
    ds_read_b128 v[144:147], v27 offset:0
    ds_read_b64_tr_b16 v[168:169], v30 offset:20480
    s_waitcnt lgkmcnt(10)
    v_mfma_f32_32x32x16_bf16 v[48:63], v[152:155], v[132:135], v[48:63]
    ds_read_b64_tr_b16 v[170:171], v30 offset:20992
    s_waitcnt lgkmcnt(9)
    v_mfma_f32_32x32x16_bf16 v[64:79], v[128:131], v[156:159], v[64:79]
    ds_read_b128 v[148:151], v27 offset:4096
    ds_read_b64_tr_b16 v[172:173], v30 offset:22528
    v_mfma_f32_32x32x16_bf16 v[80:95], v[132:135], v[156:159], v[80:95]
    ds_read_b64_tr_b16 v[174:175], v30 offset:23040
    ds_add_u32 v245, v247 offset:0
    s_waitcnt lgkmcnt(10)
    v_mfma_f32_32x32x16_bf16 v[32:47], v[160:163], v[136:139], v[32:47]
    ds_read_b128 v[128:131], v28 offset:0
    ds_read_b64_tr_b16 v[152:153], v30 offset:24576
    s_waitcnt lgkmcnt(11)
    v_mfma_f32_32x32x16_bf16 v[48:63], v[160:163], v[140:143], v[48:63]
    ds_read_b64_tr_b16 v[154:155], v30 offset:25088
    s_waitcnt lgkmcnt(10)
    v_mfma_f32_32x32x16_bf16 v[64:79], v[136:139], v[164:167], v[64:79]
    ds_read_b128 v[132:135], v28 offset:4096
    ds_read_b64_tr_b16 v[156:157], v30 offset:26624
    v_mfma_f32_32x32x16_bf16 v[80:95], v[140:143], v[164:167], v[80:95]
    ds_read_b64_tr_b16 v[158:159], v30 offset:27136
    s_waitcnt lgkmcnt(10)
    v_mfma_f32_32x32x16_bf16 v[32:47], v[168:171], v[144:147], v[32:47]
    ds_read_b128 v[136:139], v29 offset:0
    ds_read_b64_tr_b16 v[160:161], v30 offset:28672
    s_waitcnt lgkmcnt(11)
    v_mfma_f32_32x32x16_bf16 v[48:63], v[168:171], v[148:151], v[48:63]
    ds_read_b64_tr_b16 v[162:163], v30 offset:29184
    ds_read_b32 v246, v244
    s_waitcnt lgkmcnt(11)
    v_mfma_f32_32x32x16_bf16 v[64:79], v[144:147], v[172:175], v[64:79]
    ds_read_b128 v[140:143], v29 offset:4096
    ds_read_b64_tr_b16 v[164:165], v30 offset:30720
    v_mfma_f32_32x32x16_bf16 v[80:95], v[148:151], v[172:175], v[80:95]
    ds_read_b64_tr_b16 v[166:167], v30 offset:31232
    s_waitcnt lgkmcnt(10)
    v_mfma_f32_32x32x16_bf16 v[32:47], v[152:155], v[128:131], v[32:47]
    s_waitcnt lgkmcnt(3)
    s_mov_b32 s35, 4286578688
L_cl_30:
    v_cmp_gt_u32 vcc, 6, v246
    s_cbranch_vccz L_cok_31
    ds_read_b32 v246, v244 offset:0
    s_add_u32 s35, s35, 1
    s_waitcnt lgkmcnt(0)
    s_cbranch_scc0 L_cl_30
L_cok_31:
    ds_read_b128 v[144:147], v16 offset:0
    ds_read_b64_tr_b16 v[168:169], v20 offset:16384
    v_mfma_f32_32x32x16_bf16 v[48:63], v[152:155], v[132:135], v[48:63]
    ds_read_b64_tr_b16 v[170:171], v20 offset:16896
    v_mfma_f32_32x32x16_bf16 v[64:79], v[128:131], v[156:159], v[64:79]
    ds_read_b128 v[148:151], v16 offset:4096
    ds_read_b64_tr_b16 v[172:173], v20 offset:18432
    v_mfma_f32_32x32x16_bf16 v[80:95], v[132:135], v[156:159], v[80:95]
    ds_read_b64_tr_b16 v[174:175], v20 offset:18944
    buffer_load_dwordx2 v[240:241], v15, s[24:27], 0 offen sc1
    v_mfma_f32_32x32x16_bf16 v[32:47], v[160:163], v[136:139], v[32:47]
    ds_read_b128 v[128:131], v17 offset:0
    ds_read_b64_tr_b16 v[152:153], v20 offset:20480
    s_waitcnt lgkmcnt(10)
    v_mfma_f32_32x32x16_bf16 v[48:63], v[160:163], v[140:143], v[48:63]
    ds_read_b64_tr_b16 v[154:155], v20 offset:20992
    s_waitcnt lgkmcnt(9)
    v_mfma_f32_32x32x16_bf16 v[64:79], v[136:139], v[164:167], v[64:79]
    ds_read_b128 v[132:135], v17 offset:4096
    ds_read_b64_tr_b16 v[156:157], v20 offset:22528
    v_mfma_f32_32x32x16_bf16 v[80:95], v[140:143], v[164:167], v[80:95]
    ds_read_b64_tr_b16 v[158:159], v20 offset:23040
    ds_add_u32 v245, v247 offset:0
    s_waitcnt lgkmcnt(10)
    v_mfma_f32_32x32x16_bf16 v[32:47], v[168:171], v[144:147], v[32:47]
    ds_read_b128 v[136:139], v18 offset:0
    ds_read_b64_tr_b16 v[160:161], v20 offset:24576
    s_waitcnt lgkmcnt(11)
    v_mfma_f32_32x32x16_bf16 v[48:63], v[168:171], v[148:151], v[48:63]
    ds_read_b64_tr_b16 v[162:163], v20 offset:25088
    s_waitcnt lgkmcnt(10)
    v_mfma_f32_32x32x16_bf16 v[64:79], v[144:147], v[172:175], v[64:79]
    ds_read_b128 v[140:143], v18 offset:4096
    ds_read_b64_tr_b16 v[164:165], v20 offset:26624
    v_mfma_f32_32x32x16_bf16 v[80:95], v[148:151], v[172:175], v[80:95]
    ds_read_b64_tr_b16 v[166:167], v20 offset:27136
    s_waitcnt lgkmcnt(10)
    v_mfma_f32_32x32x16_bf16 v[32:47], v[152:155], v[128:131], v[32:47]
    ds_read_b128 v[144:147], v19 offset:0
    ds_read_b64_tr_b16 v[168:169], v20 offset:28672
    s_waitcnt lgkmcnt(11)
    v_mfma_f32_32x32x16_bf16 v[48:63], v[152:155], v[132:135], v[48:63]
    ds_read_b64_tr_b16 v[170:171], v20 offset:29184
    ds_read_b32 v246, v244
    s_waitcnt lgkmcnt(11)
    v_mfma_f32_32x32x16_bf16 v[64:79], v[128:131], v[156:159], v[64:79]
    ds_read_b128 v[148:151], v19 offset:4096
    ds_read_b64_tr_b16 v[172:173], v20 offset:30720
    v_mfma_f32_32x32x16_bf16 v[80:95], v[132:135], v[156:159], v[80:95]
    ds_read_b64_tr_b16 v[174:175], v20 offset:31232
    s_waitcnt lgkmcnt(10)
    v_mfma_f32_32x32x16_bf16 v[32:47], v[160:163], v[136:139], v[32:47]
    s_waitcnt lgkmcnt(3)
    s_mov_b32 s35, 4286578688
L_cl_32:
    v_cmp_gt_u32 vcc, 7, v246
    s_cbranch_vccz L_cok_33
    ds_read_b32 v246, v244 offset:0
    s_add_u32 s35, s35, 1
    s_waitcnt lgkmcnt(0)
    s_cbranch_scc0 L_cl_32
L_cok_33:
    ds_read_b128 v[128:131], v16 offset:32768
    ds_read_b64_tr_b16 v[152:153], v20 offset:49152
    v_mfma_f32_32x32x16_bf16 v[48:63], v[160:163], v[140:143], v[48:63]
    ds_read_b64_tr_b16 v[154:155], v20 offset:49664
    v_mfma_f32_32x32x16_bf16 v[64:79], v[136:139], v[164:167], v[64:79]
    ds_read_b128 v[132:135], v16 offset:36864
    ds_read_b64_tr_b16 v[200:201], v20 offset:51200
    v_mfma_f32_32x32x16_bf16 v[80:95], v[140:143], v[164:167], v[80:95]
    ds_read_b64_tr_b16 v[202:203], v20 offset:51712
    v_mfma_f32_32x32x16_bf16 v[32:47], v[168:171], v[144:147], v[32:47]
    ds_read_b128 v[136:139], v17 offset:32768
    ds_read_b64_tr_b16 v[160:161], v20 offset:53248
    s_waitcnt lgkmcnt(10)
    v_mfma_f32_32x32x16_bf16 v[48:63], v[168:171], v[148:151], v[48:63]
    ds_read_b64_tr_b16 v[162:163], v20 offset:53760
    s_waitcnt lgkmcnt(9)
    v_mfma_f32_32x32x16_bf16 v[64:79], v[144:147], v[172:175], v[64:79]
    ds_read_b128 v[140:143], v17 offset:36864
    ds_read_b64_tr_b16 v[204:205], v20 offset:55296
    v_mfma_f32_32x32x16_bf16 v[80:95], v[148:151], v[172:175], v[80:95]
    ds_read_b64_tr_b16 v[206:207], v20 offset:55808
    ds_add_u32 v245, v247 offset:0
    s_waitcnt lgkmcnt(10)
    v_mfma_f32_32x32x16_bf16 v[32:47], v[152:155], v[128:131], v[32:47]
    ds_read_b128 v[144:147], v18 offset:32768
    ds_read_b64_tr_b16 v[168:169], v20 offset:57344
    ds_read_b64_tr_b16 v[170:171], v20 offset:57856
    s_waitcnt lgkmcnt(12)
    v_mfma_f32_32x32x16_bf16 v[48:63], v[152:155], v[132:135], v[48:63]
    ds_read_b128 v[148:151], v18 offset:36864
    ds_read_b64_tr_b16 v[208:209], v20 offset:59392
    ds_read_b64_tr_b16 v[210:211], v20 offset:59904
    s_waitcnt lgkmcnt(10)
    v_mfma_f32_32x32x16_bf16 v[32:47], v[160:163], v[136:139], v[32:47]
    ds_read_b128 v[192:195], v19 offset:32768
    ds_read_b64_tr_b16 v[152:153], v20 offset:61440
    ds_read_b64_tr_b16 v[154:155], v20 offset:61952
    s_waitcnt lgkmcnt(12)
    v_mfma_f32_32x32x16_bf16 v[48:63], v[160:163], v[140:143], v[48:63]
    ds_read_b128 v[196:199], v19 offset:36864
    ds_read_b64_tr_b16 v[212:213], v20 offset:63488
    ds_read_b64_tr_b16 v[214:215], v20 offset:64000
    s_waitcnt lgkmcnt(9)
    v_mfma_f32_32x32x16_bf16 v[32:47], v[168:171], v[144:147], v[32:47]
    s_waitcnt lgkmcnt(8)
    v_mfma_f32_32x32x16_bf16 v[48:63], v[168:171], v[148:151], v[48:63]
    ds_read_b32 v246, v244 offset:512
    s_waitcnt lgkmcnt(4)
    v_mfma_f32_32x32x16_bf16 v[32:47], v[152:155], v[192:195], v[32:47]
    s_waitcnt lgkmcnt(3)
    v_mfma_f32_32x32x16_bf16 v[48:63], v[152:155], v[196:199], v[48:63]
    s_waitcnt lgkmcnt(0)
    ds_add_u32 v245, v247 offset:0
    v_mfma_f32_32x32x16_bf16 v[80:95], v[132:135], v[200:203], v[80:95]
    v_mov_b32 v10, 0x3f803f80
    s_mov_b32 s64, 0x10000000
    s_mov_b32 s65, 0x10000000
    s_add_u32 s63, s67, s37
    s_add_u32 s62, s63, 4096
    v_mfma_f32_32x32x16_bf16 v[80:95], v[140:143], v[204:207], v[80:95]
    s_bitcmp1_b32 s31, 0
    s_cselect_b32 s62, s62, 0x7ff00000
    s_nop 1
    v_cvt_pk_bf16_f32 v48, v48, v49
    v_cvt_pk_bf16_f32 v49, v50, v51
    v_mfma_f32_32x32x16_bf16 v[80:95], v[148:151], v[208:211], v[80:95]
    v_cvt_pk_bf16_f32 v50, v52, v53
    v_cvt_pk_bf16_f32 v51, v54, v55
    v_cvt_pk_bf16_f32 v52, v56, v57
    v_cvt_pk_bf16_f32 v53, v58, v59
    v_mfma_f32_32x32x16_bf16 v[80:95], v[196:199], v[212:215], v[80:95]
    v_cvt_pk_bf16_f32 v54, v60, v61
    v_cvt_pk_bf16_f32 v55, v62, v63
    v_cndmask_b32 v54, v54, v10, s[68:69]
    buffer_store_dwordx4 v[48:51], v9, s[16:19], s62 offen offset:0 sc1
    v_mfma_f32_32x32x16_bf16 v[64:79], v[128:131], v[200:203], v[64:79]
    buffer_store_dwordx4 v[52:55], v9, s[16:19], s62 offen offset:1024 sc1
    v_cvt_pk_bf16_f32 v32, v32, v33
    v_cvt_pk_bf16_f32 v33, v34, v35
    v_cvt_pk_bf16_f32 v34, v36, v37
    v_mfma_f32_32x32x16_bf16 v[64:79], v[136:139], v[204:207], v[64:79]
    v_cvt_pk_bf16_f32 v35, v38, v39
    v_cvt_pk_bf16_f32 v36, v40, v41
    v_cvt_pk_bf16_f32 v37, v42, v43
    v_cvt_pk_bf16_f32 v38, v44, v45
    v_mfma_f32_32x32x16_bf16 v[64:79], v[144:147], v[208:211], v[64:79]
    v_cvt_pk_bf16_f32 v39, v46, v47
    v_cndmask_b32 v38, v38, v10, s[68:69]
    v_mfma_f32_32x32x16_bf16 v[64:79], v[192:195], v[212:215], v[64:79]
    s_mov_b32 s35, 4286578688
L_cl_34:
    v_cmp_gt_u32 vcc, 5, v246
    s_cbranch_vccz L_cok_35
    ds_read_b32 v246, v244 offset:512
    s_add_u32 s35, s35, 1
    s_waitcnt lgkmcnt(0)
    s_cbranch_scc0 L_cl_34
L_cok_35:
    v_cvt_pk_bf16_f32 v80, v80, v81
    v_cvt_pk_bf16_f32 v81, v82, v83
    v_cvt_pk_bf16_f32 v82, v84, v85
    v_cvt_pk_bf16_f32 v83, v86, v87
    v_cndmask_b32 v80, v80, v10, s[64:65]
    v_cndmask_b32 v81, v81, v10, s[64:65]
    v_cndmask_b32 v82, v82, v10, s[64:65]
    v_cndmask_b32 v83, v83, v10, s[64:65]
    buffer_store_dwordx4 v[80:83], v9, s[16:19], s62 offen offset:2048 sc1
    v_cvt_pk_bf16_f32 v84, v88, v89
    v_cvt_pk_bf16_f32 v85, v90, v91
    v_cvt_pk_bf16_f32 v86, v92, v93
    v_cvt_pk_bf16_f32 v87, v94, v95
    v_cndmask_b32 v84, v84, v10, s[64:65]
    v_cndmask_b32 v85, v85, v10, s[64:65]
    v_cndmask_b32 v86, v86, v10, s[64:65]
    v_cndmask_b32 v87, v87, v10, s[64:65]
    buffer_store_dwordx4 v[84:87], v9, s[16:19], s62 offen offset:3072 sc1
    v_cvt_pk_bf16_f32 v64, v64, v65
    v_cvt_pk_bf16_f32 v65, v66, v67
    v_cvt_pk_bf16_f32 v66, v68, v69
    v_cvt_pk_bf16_f32 v67, v70, v71
    v_cndmask_b32 v64, v64, v10, s[64:65]
    v_cndmask_b32 v65, v65, v10, s[64:65]
    v_cndmask_b32 v66, v66, v10, s[64:65]
    v_cndmask_b32 v67, v67, v10, s[64:65]
    v_cvt_pk_bf16_f32 v68, v72, v73
    v_cvt_pk_bf16_f32 v69, v74, v75
    v_cvt_pk_bf16_f32 v70, v76, v77
    v_cvt_pk_bf16_f32 v71, v78, v79
    v_cndmask_b32 v68, v68, v10, s[64:65]
    v_cndmask_b32 v69, v69, v10, s[64:65]
    v_cndmask_b32 v70, v70, v10, s[64:65]
    v_cndmask_b32 v71, v71, v10, s[64:65]
    ds_add_u32 v250, v247 offset:116
    ds_write_b128 v2, v[32:35] offset:0
    ds_write_b128 v2, v[36:39] offset:1024
    ds_write_b128 v2, v[64:67] offset:2048
    ds_write_b128 v2, v[68:71] offset:3072
    ds_write_b128 v2, v[48:51] offset:4096
    ds_write_b128 v2, v[52:55] offset:5120
    ds_write_b128 v2, v[80:83] offset:6144
    ds_write_b128 v2, v[84:87] offset:7168
    s_lshl_b32 s62, s51, 14
    s_lshl_b32 s63, s50, 12
    s_add_u32 s62, s62, s63
    s_add_u32 s62, s62, 131072
    v_add_u32 v176, s62, v9
    s_mov_b32 s63, 0xfffeb000
    s_cmp_eq_u32 s50, 0
    s_cselect_b32 s62, s63, 0xfffff000
    v_add_u32 v177, s62, v176
    v_lshrrev_b32 v10, 4, v1
    v_lshlrev_b32 v11, 2, v10
    v_and_b32 v12, 15, v1
    v_xor_b32 v11, v11, v12
    v_mul_u32_u24 v248, 896, v10
    v_lshl_add_u32 v248, v11, 4, v248
    s_cmp_eq_u32 s32, 3
    s_cselect_b32 s62, 8, 64
    v_mov_b32 v12, 0x7ff00000
    v_cmp_le_u32 vcc, s62, v11
    s_lshl_b32 s63, s51, 7
    v_add_u32 v251, s63, v249
    v_cndmask_b32 v248, v248, v12, vcc
    s_waitcnt lgkmcnt(0)
    ds_add_u32 v250, v247 offset:636
    s_lshr_b32 s63, s59, 8
    s_lshl_b32 s64, s31, 3
    s_add_u32 s63, s63, s64
    s_add_u32 s63, s63, 0x1000000
    s_waitcnt vmcnt(0)
    s_mov_b32 s35, 0
L_nlp_36:
    v_readfirstlane_b32 s60, v240
    v_readfirstlane_b32 s61, v241
    s_add_u32 s35, s35, 1
    s_cmp_lg_u32 s60, 0
    s_cbranch_scc1 L_nok_37
    s_cmp_gt_u32 s35, 1048576
    s_cbranch_scc1 L_nok_37
    buffer_load_dwordx2 v[240:241], v15, s[24:27], 0 offen sc1
    s_waitcnt vmcnt(0)
    s_branch L_nlp_36
L_nok_37:
    s_mov_b64 exec, 1
    buffer_store_dwordx2 v[240:241], v15, s[16:19], s63 offen sc1
    s_mov_b64 exec, -1
    v_mov_b32 v10, 0xf149f2ca
    s_mov_b32 s64, 0x00005555
    s_mov_b32 s65, 0x00055550
    v_cndmask_b32 v96, v10, 0, s[64:65]
    s_mov_b32 s64, 0x00000000
    s_mov_b32 s65, 0x00000000
    v_cndmask_b32 v112, v10, 0, s[64:65]
    s_mov_b32 s64, 0x0000aaaa
    s_mov_b32 s65, 0x000aaaa0
    v_cndmask_b32 v97, v10, 0, s[64:65]
    s_mov_b32 s64, 0x00000000
    s_mov_b32 s65, 0x00000000
    v_cndmask_b32 v113, v10, 0, s[64:65]
    s_mov_b32 s64, 0x00015554
    s_mov_b32 s65, 0x00155540
    v_cndmask_b32 v98, v10, 0, s[64:65]
    s_mov_b32 s64, 0x00000000
    s_mov_b32 s65, 0x00000000
    v_cndmask_b32 v114, v10, 0, s[64:65]
    s_mov_b32 s64, 0x0002aaa8
    s_mov_b32 s65, 0x002aaa80
    v_cndmask_b32 v99, v10, 0, s[64:65]
    s_mov_b32 s64, 0x00000000
    s_mov_b32 s65, 0x00000000
    v_cndmask_b32 v115, v10, 0, s[64:65]
    s_mov_b32 s64, 0x00555500
    s_mov_b32 s65, 0x05555000
    v_cndmask_b32 v100, v10, 0, s[64:65]
    s_mov_b32 s64, 0x00000000
    s_mov_b32 s65, 0x00000000
    v_cndmask_b32 v116, v10, 0, s[64:65]
    s_mov_b32 s64, 0x00aaaa00
    s_mov_b32 s65, 0x0aaaa000
    v_cndmask_b32 v101, v10, 0, s[64:65]
    s_mov_b32 s64, 0x00000000
    s_mov_b32 s65, 0x00000000
    v_cndmask_b32 v117, v10, 0, s[64:65]
    s_mov_b32 s64, 0x01555400
    s_mov_b32 s65, 0x15554000
    v_cndmask_b32 v102, v10, 0, s[64:65]
    s_mov_b32 s64, 0x00000000
    s_mov_b32 s65, 0x00000000
    v_cndmask_b32 v118, v10, 0, s[64:65]
    s_mov_b32 s64, 0x02aaa800
    s_mov_b32 s65, 0x2aaa8000
    v_cndmask_b32 v103, v10, 0, s[64:65]
    s_mov_b32 s64, 0x00000000
    s_mov_b32 s65, 0x00000000
    v_cndmask_b32 v119, v10, 0, s[64:65]
    s_mov_b32 s64, 0x55550000
    s_mov_b32 s65, 0x55500000
    v_cndmask_b32 v104, v10, 0, s[64:65]
    s_mov_b32 s64, 0x00000000
    s_mov_b32 s65, 0x00000005
    v_cndmask_b32 v120, v10, 0, s[64:65]
    s_mov_b32 s64, 0xaaaa0000
    s_mov_b32 s65, 0xaaa00000
    v_cndmask_b32 v105, v10, 0, s[64:65]
    s_mov_b32 s64, 0x00000000
    s_mov_b32 s65, 0x0000000a
    v_cndmask_b32 v121, v10, 0, s[64:65]
    s_mov_b32 s64, 0x55540000
    s_mov_b32 s65, 0x55400000
    v_cndmask_b32 v106, v10, 0, s[64:65]
    s_mov_b32 s64, 0x00000001
    s_mov_b32 s65, 0x00000015
    v_cndmask_b32 v122, v10, 0, s[64:65]
    s_mov_b32 s64, 0xaaa80000
    s_mov_b32 s65, 0xaa800000
    v_cndmask_b32 v107, v10, 0, s[64:65]
    s_mov_b32 s64, 0x00000002
    s_mov_b32 s65, 0x0000002a
    v_cndmask_b32 v123, v10, 0, s[64:65]
    s_mov_b32 s64, 0x55000000
    s_mov_b32 s65, 0x50000000
    v_cndmask_b32 v108, v10, 0, s[64:65]
    s_mov_b32 s64, 0x00000055
    s_mov_b32 s65, 0x00000555
    v_cndmask_b32 v124, v10, 0, s[64:65]
    s_mov_b32 s64, 0xaa000000
    s_mov_b32 s65, 0xa0000000
    v_cndmask_b32 v109, v10, 0, s[64:65]
    s_mov_b32 s64, 0x000000aa
    s_mov_b32 s65, 0x00000aaa
    v_cndmask_b32 v125, v10, 0, s[64:65]
    s_mov_b32 s64, 0x54000000
    s_mov_b32 s65, 0x40000000
    v_cndmask_b32 v110, v10, 0, s[64:65]
    s_mov_b32 s64, 0x00000155
    s_mov_b32 s65, 0x00001555
    v_cndmask_b32 v126, v10, 0, s[64:65]
    s_mov_b32 s64, 0xa8000000
    s_mov_b32 s65, 0x80000000
    v_cndmask_b32 v111, v10, 0, s[64:65]
    s_mov_b32 s64, 0x000002aa
    s_mov_b32 s65, 0x00002aaa
    v_cndmask_b32 v127, v10, 0, s[64:65]
    s_or_b32 s62, s30, s50
    s_cmp_lg_u32 s62, 0
    s_cbranch_scc1 L_c2_39
    v_mov_b32 v112, v10
    v_mov_b32 v113, v10
    v_mov_b32 v114, v10
    v_mov_b32 v115, v10
    v_mov_b32 v116, v10
    v_mov_b32 v117, v10
    v_mov_b32 v118, v10
    v_mov_b32 v119, v10
    v_mov_b32 v120, v10
    v_mov_b32 v121, v10
    v_mov_b32 v122, v10
    v_mov_b32 v123, v10
    v_mov_b32 v124, v10
    v_mov_b32 v125, v10
    v_mov_b32 v126, v10
    v_mov_b32 v127, v10
L_c2_39:
    s_cmp_lt_u32 s31, 2
    s_cbranch_scc1 L_ldd_38
    s_lshr_b32 s65, s50, 1
    s_mov_b32 s35, 0
L_spin_40:
    ds_read_b32 v246, v244 offset:512
    s_add_u32 s35, s35, 1
    s_waitcnt lgkmcnt(0)
    v_cmp_gt_u32 vcc, 7, v246
    s_cmp_gt_u32 s35, 8388608
    s_cbranch_scc1 L_spok_41
    s_cbranch_vccnz L_spin_40
L_spok_41:
    s_mov_b32 s35, 0
L_spin_42:
    ds_read_b32 v246, v249 offset:956
    s_add_u32 s35, s35, 1
    s_waitcnt lgkmcnt(0)
    v_cmp_gt_u32 vcc, 4, v246
    s_cmp_gt_u32 s35, 8388608
    s_cbranch_scc1 L_spok_43
    s_cbranch_vccnz L_spin_42
L_spok_43:
    s_and_b32 s64, s50, 1
    s_add_u32 s67, s65, 1
    s_lshl_b32 s62, s67, 15
    s_sub_u32 s54, s59, s62
    s_lshr_b32 s62, s54, 8
    s_lshl_b32 s63, s64, 4
    s_add_u32 s62, s62, s63
    s_add_u32 s62, s62, 0x1000000
    v_and_b32 v10, 1, v1
    v_lshlrev_b32 v10, 3, v10
    v_add_u32 v10, s62, v10
    v_and_b32 v11, 2, v1
    v_lshl_add_u32 v10, v11, 5, v10
    s_lshl_b32 s62, s50, 7
    s_lshl_b32 s63, s65, 6
    s_sub_u32 s62, s62, s63
    s_add_u32 s62, s62, 124
    v_add_u32 v245, s62, v250
    s_mul_i32 s62, s67, 33280
    s_sub_u32 s62, s37, s62
    s_lshl_b32 s64, s64, 14
    s_add_u32 s56, s62, s64
    s_lshl_b32 s62, s65, 15
    s_sub_u32 s62, 32768, s62
    s_add_u32 s64, s64, s62
    s_cmp_lt_u32 s30, s67
    s_cselect_b32 s56, 0x7ff00000, s56
    s_cmp_lt_u32 s30, s67
    s_cbranch_scc1 L_nopoll_44
    s_mov_b64 exec, 2
    s_mov_b32 s35, 0
L_poll_45:
    buffer_load_dwordx2 v[242:243], v10, s[16:19], 0 offen sc1
    s_add_u32 s35, s35, 1
    s_waitcnt vmcnt(0)
    v_cmp_ne_u64 vcc, s[60:61], v[242:243]
    s_cmp_gt_u32 s35, 1048576
    s_cbranch_scc1 L_pok_46
    s_cbranch_vccnz L_poll_45
L_pok_46:
    s_mov_b64 exec, -1
L_nopoll_44:
    s_add_u32 m0, s64, 12288
    s_add_u32 s62, s56, 12288
    buffer_load_dwordx4 v9, s[16:19], s62 offen offset:0 sc1 lds
    buffer_load_dwordx4 v9, s[16:19], s62 offen offset:1024 sc1 lds
    buffer_load_dwordx4 v9, s[16:19], s62 offen offset:2048 sc1 lds
    buffer_load_dwordx4 v9, s[16:19], s62 offen offset:3072 sc1 lds
    s_waitcnt vmcnt(0)
    ds_add_u32 v245, v247 offset:0
L_ldd_38:
    s_lshl_b32 s62, s50, 11
    s_add_u32 s62, s62, 122880
    v_add_u32 v10, s62, v9
    s_mov_b32 s35, 0
L_spin_47:
    ds_read_b32 v246, v249 offset:636
    s_add_u32 s35, s35, 1
    s_waitcnt lgkmcnt(0)
    v_cmp_gt_u32 vcc, 4, v246
    s_cmp_gt_u32 s35, 8388608
    s_cbranch_scc1 L_spok_48
    s_cbranch_vccnz L_spin_47
L_spok_48:
    s_mov_b32 s35, 0
L_spin_49:
    ds_read_b32 v246, v249 offset:764
    s_add_u32 s35, s35, 1
    s_waitcnt lgkmcnt(0)
    v_cmp_gt_u32 vcc, 4, v246
    s_cmp_gt_u32 s35, 8388608
    s_cbranch_scc1 L_spok_50
    s_cbranch_vccnz L_spin_49
L_spok_50:
    ds_read_b128 v[16:19], v10 offset:0
    ds_read_b128 v[20:23], v10 offset:1024
L_xB:
    ds_read_b128 v[48:51], v176 offset:0
    ds_read_b128 v[52:55], v176 offset:1024
    ds_read_b128 v[64:67], v176 offset:2048
    ds_read_b128 v[68:71], v176 offset:3072
    s_waitcnt lgkmcnt(2)
    v_mfma_f32_32x32x16_bf16 v[128:143], v[48:51], v[16:19], v[96:111]
    v_mfma_f32_32x32x16_bf16 v[128:143], v[52:55], v[20:23], v[128:143]
    ds_add_u32 v250, v247 offset:828
    s_cmp_lg_u32 s50, 0
    s_cbranch_scc1 L_bs_51
    s_mov_b32 s35, 0
L_spin_52:
    ds_read_b32 v252, v251 offset:124
    s_add_u32 s35, s35, 1
    s_waitcnt lgkmcnt(0)
    v_cmp_gt_u32 vcc, 1, v252
    s_cmp_gt_u32 s35, 8388608
    s_cbranch_scc1 L_spok_53
    s_cbranch_vccnz L_spin_52
L_spok_53:
L_bs_51:
    ds_read_b128 v[56:59], v177 offset:0
    ds_read_b128 v[60:63], v177 offset:1024
    ds_read_b128 v[72:75], v177 offset:2048
    ds_read_b128 v[76:79], v177 offset:3072
    s_waitcnt lgkmcnt(2)
    v_mfma_f32_32x32x16_bf16 v[144:159], v[56:59], v[16:19], v[112:127]
    v_mfma_f32_32x32x16_bf16 v[144:159], v[60:63], v[20:23], v[144:159]
    s_nop 4
    v_max3_f32 v80, v128, v129, v130
    v_max3_f32 v80, v80, v131, v132
    v_max3_f32 v80, v80, v133, v134
    v_max3_f32 v80, v80, v135, v136
    v_max3_f32 v80, v80, v137, v138
    v_max3_f32 v80, v80, v139, v140
    v_max3_f32 v80, v80, v141, v142
    v_max_f32 v80, v80, v143
    s_nop 0
    v_max3_f32 v80, v80, v144, v145
    v_max3_f32 v80, v80, v146, v147
    v_max3_f32 v80, v80, v148, v149
    v_max3_f32 v80, v80, v150, v151
    v_max3_f32 v80, v80, v152, v153
    v_max3_f32 v80, v80, v154, v155
    v_max3_f32 v80, v80, v156, v157
    v_max3_f32 v80, v80, v158, v159
    v_mov_b32 v81, v80
    s_nop 1
    v_permlane32_swap_b32 v80, v81
    s_nop 1
    v_max_f32 v80, v80, v81
    v_sub_f32 v128, v128, v80
    v_sub_f32 v129, v129, v80
    v_sub_f32 v130, v130, v80
    v_sub_f32 v131, v131, v80
    v_sub_f32 v132, v132, v80
    v_sub_f32 v133, v133, v80
    v_sub_f32 v134, v134, v80
    v_sub_f32 v135, v135, v80
    v_sub_f32 v136, v136, v80
    v_sub_f32 v137, v137, v80
    v_sub_f32 v138, v138, v80
    v_sub_f32 v139, v139, v80
    v_sub_f32 v140, v140, v80
    v_sub_f32 v141, v141, v80
    v_sub_f32 v142, v142, v80
    v_sub_f32 v143, v143, v80
    v_sub_f32 v144, v144, v80
    v_sub_f32 v145, v145, v80
    v_sub_f32 v146, v146, v80
    v_sub_f32 v147, v147, v80
    v_sub_f32 v148, v148, v80
    v_sub_f32 v149, v149, v80
    v_sub_f32 v150, v150, v80
    v_sub_f32 v151, v151, v80
    v_sub_f32 v152, v152, v80
    v_sub_f32 v153, v153, v80
    v_sub_f32 v154, v154, v80
    v_sub_f32 v155, v155, v80
    v_sub_f32 v156, v156, v80
    v_sub_f32 v157, v157, v80
    v_sub_f32 v158, v158, v80
    v_sub_f32 v159, v159, v80
    v_exp_f32 v128, v128
    v_exp_f32 v129, v129
    v_exp_f32 v130, v130
    v_exp_f32 v131, v131
    v_exp_f32 v132, v132
    v_exp_f32 v133, v133
    v_exp_f32 v134, v134
    v_exp_f32 v135, v135
    v_exp_f32 v136, v136
    v_exp_f32 v137, v137
    v_exp_f32 v138, v138
    v_exp_f32 v139, v139
    v_exp_f32 v140, v140
    v_exp_f32 v141, v141
    v_exp_f32 v142, v142
    v_exp_f32 v143, v143
    s_nop 0
    v_cvt_pk_bf16_f32 v128, v128, v129
    v_cvt_pk_bf16_f32 v129, v130, v131
    v_cvt_pk_bf16_f32 v130, v132, v133
    v_cvt_pk_bf16_f32 v131, v134, v135
    v_cvt_pk_bf16_f32 v132, v136, v137
    v_cvt_pk_bf16_f32 v133, v138, v139
    v_cvt_pk_bf16_f32 v134, v140, v141
    v_cvt_pk_bf16_f32 v135, v142, v143
    s_waitcnt lgkmcnt(0)
    s_nop 0
    v_mfma_f32_32x32x16_bf16 v[32:47], v[64:67], v[128:131], 0
    v_mfma_f32_32x32x16_bf16 v[32:47], v[68:71], v[132:135], v[32:47]
    v_exp_f32 v144, v144
    v_exp_f32 v145, v145
    v_exp_f32 v146, v146
    v_exp_f32 v147, v147
    v_exp_f32 v148, v148
    v_exp_f32 v149, v149
    v_exp_f32 v150, v150
    v_exp_f32 v151, v151
    v_exp_f32 v152, v152
    v_exp_f32 v153, v153
    v_exp_f32 v154, v154
    v_exp_f32 v155, v155
    v_exp_f32 v156, v156
    v_exp_f32 v157, v157
    v_exp_f32 v158, v158
    v_exp_f32 v159, v159
    s_nop 0
    v_cvt_pk_bf16_f32 v144, v144, v145
    v_cvt_pk_bf16_f32 v145, v146, v147
    v_cvt_pk_bf16_f32 v146, v148, v149
    v_cvt_pk_bf16_f32 v147, v150, v151
    v_cvt_pk_bf16_f32 v148, v152, v153
    v_cvt_pk_bf16_f32 v149, v154, v155
    v_cvt_pk_bf16_f32 v150, v156, v157
    v_cvt_pk_bf16_f32 v151, v158, v159
    s_waitcnt lgkmcnt(0)
    s_nop 0
    v_mfma_f32_32x32x16_bf16 v[32:47], v[72:75], v[144:147], v[32:47]
    v_mfma_f32_32x32x16_bf16 v[32:47], v[76:79], v[148:151], v[32:47]
    s_nop 11
    v_mov_b32 v80, v44
    v_mov_b32 v81, v44
    s_nop 1
    v_permlane32_swap_b32 v80, v81
    s_nop 1
    v_rcp_f32 v80, v81
    s_lshl_b32 s62, s28, 6
    s_lshl_b32 s63, s30, 2
    s_add_u32 s62, s62, s63
    v_cndmask_b32 v81, v80, 0, s[68:69]
    s_add_u32 s62, s62, s50
    s_mul_i32 s62, s62, 33280
    s_lshl_b32 s63, s29, 1
    s_add_u32 s63, s63, s51
    s_lshl_b32 s63, s63, 11
    s_add_u32 s62, s62, s63
    s_add_u32 s62, s62, 0xa00000
    v_mul_f32 v32, v80, v32
    v_mul_f32 v33, v80, v33
    v_mul_f32 v34, v80, v34
    v_mul_f32 v35, v80, v35
    v_mul_f32 v36, v80, v36
    v_mul_f32 v37, v80, v37
    v_mul_f32 v38, v80, v38
    v_mul_f32 v39, v80, v39
    v_cvt_pk_bf16_f32 v84, v32, v33
    v_cvt_pk_bf16_f32 v85, v34, v35
    v_cvt_pk_bf16_f32 v86, v36, v37
    v_cvt_pk_bf16_f32 v87, v38, v39
    buffer_store_dwordx4 v[84:87], v9, s[16:19], s62 offen offset:0 sc1
    v_mul_f32 v40, v80, v40
    v_mul_f32 v41, v80, v41
    v_mul_f32 v42, v80, v42
    v_mul_f32 v43, v80, v43
    v_mul_f32 v44, v81, v44
    v_mul_f32 v45, v81, v45
    v_mul_f32 v46, v81, v46
    v_mul_f32 v47, v81, v47
    v_cvt_pk_bf16_f32 v88, v40, v41
    v_cvt_pk_bf16_f32 v89, v42, v43
    v_cvt_pk_bf16_f32 v90, v44, v45
    v_cvt_pk_bf16_f32 v91, v46, v47
    buffer_store_dwordx4 v[88:91], v9, s[16:19], s62 offen offset:1024 sc1
    s_mov_b32 s35, 0
L_spin_54:
    ds_read_b32 v254, v249 offset:828
    s_add_u32 s35, s35, 1
    s_waitcnt lgkmcnt(0)
    v_cmp_gt_u32 vcc, 8, v254
    s_cmp_gt_u32 s35, 8388608
    s_cbranch_scc1 L_spok_55
    s_cbranch_vccnz L_spin_54
L_spok_55:
    s_add_u32 m0, s52, 65536
    s_add_u32 s65, s34, 0
    buffer_load_dwordx4 v248, s[12:15], s65 offen lds
    s_add_u32 m0, s52, 73728
    s_add_u32 s65, s34, 28672
    buffer_load_dwordx4 v248, s[12:15], s65 offen lds
    s_add_u32 m0, s52, 81920
    s_add_u32 s65, s34, 57344
    buffer_load_dwordx4 v248, s[12:15], s65 offen lds
    s_cmp_eq_u32 s31, 7
    s_cbranch_scc1 L_wsk_59
    s_add_u32 m0, s52, 90112
    s_add_u32 s65, s34, 86016
    buffer_load_dwordx4 v248, s[12:15], s65 offen lds
L_wsk_59:
    s_add_u32 m0, s52, 98304
    s_add_u32 s65, s34, 107520
    buffer_load_dwordx4 v248, s[12:15], s65 offen lds
    s_add_u32 m0, s52, 106496
    s_add_u32 s65, s34, 136192
    buffer_load_dwordx4 v248, s[12:15], s65 offen lds
    s_add_u32 m0, s52, 114688
    s_add_u32 s65, s34, 164864
    buffer_load_dwordx4 v248, s[12:15], s65 offen lds
    s_add_u32 m0, s52, 122880
    s_add_u32 s65, s34, 193536
    buffer_load_dwordx4 v248, s[12:15], s65 offen lds
    s_branch L_p3
L_A:
    s_cmp_lt_u32 s31, 4
    s_cbranch_scc1 L_consA
    s_mov_b32 s38, 0xf7f77f7f
    s_mov_b32 s39, 0xf7f77f7f
    s_cmp_eq_u32 s31, 7
    s_cselect_b64 s[38:39], s[38:39], -1
    s_waitcnt vmcnt(8)
    ds_add_u32 v245, v247 offset:0
    ds_read_b128 v[128:131], v4 offset:0
    ds_read_b128 v[132:135], v5 offset:0
    ds_read_b128 v[136:139], v6 offset:0
    ds_read_b128 v[140:143], v7 offset:0
    s_add_u32 m0, s57, 65536
    s_add_u32 s54, s54, 128
    buffer_load_dwordx4 v16, s[4:7], s54 offen lds
    buffer_load_dwordx4 v17, s[4:7], s54 offen offset:1024 lds
    buffer_load_dwordx4 v18, s[4:7], s54 offen offset:2048 lds
    buffer_load_dwordx4 v19, s[4:7], s54 offen offset:3072 lds
    s_add_u32 m0, s57, 81920
    s_add_u32 s56, s56, 172032
    buffer_load_dwordx4 v20, s[8:11], s56 offen lds
    buffer_load_dwordx4 v21, s[8:11], s56 offen offset:1024 lds
    buffer_load_dwordx4 v22, s[8:11], s56 offen offset:2048 lds
    s_mov_b64 exec, s[38:39]
    buffer_load_dwordx4 v23, s[8:11], s56 offen offset:3072 lds
    s_mov_b64 exec, -1
    v_add_u32 v64, 0x10000, v4
    v_add_u32 v65, 0x10000, v5
    v_add_u32 v66, 0x10000, v6
    v_add_u32 v67, 0x10000, v7
    v_add_u32 v68, 0x20000, v4
    v_add_u32 v69, 0x20000, v5
    v_add_u32 v70, 0x20000, v6
    v_add_u32 v71, 0x20000, v7
    s_mov_b32 s24, s46
    s_mov_b32 s25, s47
    s_mov_b32 s26, 256
    s_mov_b32 s27, 0x20000
    v_mov_b32 v15, 0
    v_lshlrev_b32 v9, 4, v1
    s_cmp_eq_u32 s28, 0
    s_cselect_b32 s12, s36, s42
    s_cselect_b32 s13, s37, s43
    s_mov_b32 s14, 0x62000
    s_mov_b32 s15, 0x20000
    s_mov_b32 s16, s48
    s_mov_b32 s17, s49
    s_mov_b32 s18, 0x2400000
    s_mov_b32 s19, 0x20000
    s_mov_b32 s20, s44
    s_mov_b32 s21, s45
    s_mov_b32 s22, 0x380000
    s_mov_b32 s23, 0x20000
    s_mov_b32 s68, 0
    s_mov_b32 s69, -1
    s_mov_b32 s66, 0x3e8b97f6
    s_lshl_b32 s52, s31, 10
    s_lshr_b32 s51, s31, 2
    s_sub_u32 s63, 3, s55
    s_cmp_lt_u32 s31, 4
    s_cselect_b32 s50, s63, s55
    s_lshl_b32 s59, s28, 3
    s_add_u32 s59, s59, s29
    s_lshl_b32 s59, s59, 4
    s_add_u32 s59, s59, s30
    s_mul_i32 s37, s59, 33280
    s_lshl_b32 s59, s59, 15
    s_and_b32 s32, s29, 3
    s_lshr_b32 s62, s29, 2
    s_lshl_b32 s33, s30, 1
    s_add_u32 s33, s33, s62
    s_mul_i32 s34, s31, 3584
    s_lshl_b32 s62, s32, 8
    s_add_u32 s34, s34, s62
    s_waitcnt vmcnt(8)
    s_waitcnt lgkmcnt(0)
    ds_add_u32 v245, v247 offset:0
    ds_read_b128 v[144:147], v4 offset:32768
    ds_read_b128 v[148:151], v5 offset:32768
    ds_read_b128 v[152:155], v6 offset:32768
    ds_read_b128 v[156:159], v7 offset:32768
    s_add_u32 m0, s57, 98304
    s_add_u32 s54, s54, 128
    buffer_load_dwordx4 v16, s[4:7], s54 offen lds
    buffer_load_dwordx4 v17, s[4:7], s54 offen offset:1024 lds
    buffer_load_dwordx4 v18, s[4:7], s54 offen offset:2048 lds
    buffer_load_dwordx4 v19, s[4:7], s54 offen offset:3072 lds
    s_add_u32 m0, s57, 114688
    s_add_u32 s56, s56, 172032
    buffer_load_dwordx4 v20, s[8:11], s56 offen lds
    buffer_load_dwordx4 v21, s[8:11], s56 offen offset:1024 lds
    buffer_load_dwordx4 v22, s[8:11], s56 offen offset:2048 lds
    buffer_load_dwordx4 v23, s[8:11], s56 offen offset:3072 lds
    v_bfe_u32 v10, v1, 2, 2
    v_lshrrev_b32 v12, 5, v1
    v_lshl_add_u32 v11, v12, 3, v10
    v_lshlrev_b32 v11, 7, v11
    v_lshrrev_b32 v10, 1, v10
    v_lshlrev_b32 v10, 6, v10
    v_and_b32 v12, 3, v1
    v_lshlrev_b32 v12, 3, v12
    v_and_b32 v8, 16, v1
    v_lshl_add_u32 v12, v8, 1, v12
    v_add_u32 v12, 0, v12
    v_xor_b32 v12, v12, v10
    v_add_u32 v8, v11, v12
    v_add_u32 v8, 65536, v8
    v_bfe_u32 v10, v1, 2, 2
    v_lshrrev_b32 v12, 5, v1
    v_lshl_add_u32 v11, v12, 3, v10
    v_lshlrev_b32 v11, 7, v11
    v_lshrrev_b32 v10, 1, v10
    v_lshlrev_b32 v10, 6, v10
    v_and_b32 v12, 3, v1
    v_lshlrev_b32 v12, 3, v12
    v_and_b32 v3, 16, v1
    v_lshl_add_u32 v12, v3, 1, v12
    v_add_u32 v12, 56, v12
    v_xor_b32 v12, v12, v10
    v_add_u32 v3, v11, v12
    v_add_u32 v3, 65536, v3
    v_mov_b32 v10, 0xf149f2ca
    s_mov_b32 s64, 0xffffffff
    s_mov_b32 s65, 0xfffffff0
    v_cndmask_b32 v96, v10, 0, s[64:65]
    v_cndmask_b32 v112, 0, v10, s[64:65]
    s_mov_b32 s64, 0xfffffffe
    s_mov_b32 s65, 0xffffffe0
    v_cndmask_b32 v97, v10, 0, s[64:65]
    v_cndmask_b32 v113, 0, v10, s[64:65]
    s_mov_b32 s64, 0xfffffffc
    s_mov_b32 s65, 0xffffffc0
    v_cndmask_b32 v98, v10, 0, s[64:65]
    v_cndmask_b32 v114, 0, v10, s[64:65]
    s_mov_b32 s64, 0xfffffff8
    s_mov_b32 s65, 0xffffff80
    v_cndmask_b32 v99, v10, 0, s[64:65]
    v_cndmask_b32 v115, 0, v10, s[64:65]
    s_mov_b32 s64, 0xffffff00
    s_mov_b32 s65, 0xfffff000
    v_cndmask_b32 v100, v10, 0, s[64:65]
    v_cndmask_b32 v116, 0, v10, s[64:65]
    s_mov_b32 s64, 0xfffffe00
    s_mov_b32 s65, 0xffffe000
    v_cndmask_b32 v101, v10, 0, s[64:65]
    v_cndmask_b32 v117, 0, v10, s[64:65]
    s_mov_b32 s64, 0xfffffc00
    s_mov_b32 s65, 0xffffc000
    v_cndmask_b32 v102, v10, 0, s[64:65]
    v_cndmask_b32 v118, 0, v10, s[64:65]
    s_mov_b32 s64, 0xfffff800
    s_mov_b32 s65, 0xffff8000
    v_cndmask_b32 v103, v10, 0, s[64:65]
    v_cndmask_b32 v119, 0, v10, s[64:65]
    s_mov_b32 s64, 0xffff0000
    s_mov_b32 s65, 0xfff00000
    v_cndmask_b32 v104, v10, 0, s[64:65]
    v_cndmask_b32 v120, 0, v10, s[64:65]
    s_mov_b32 s64, 0xfffe0000
    s_mov_b32 s65, 0xffe00000
    v_cndmask_b32 v105, v10, 0, s[64:65]
    v_cndmask_b32 v121, 0, v10, s[64:65]
    s_mov_b32 s64, 0xfffc0000
    s_mov_b32 s65, 0xffc00000
    v_cndmask_b32 v106, v10, 0, s[64:65]
    v_cndmask_b32 v122, 0, v10, s[64:65]
    s_mov_b32 s64, 0xfff80000
    s_mov_b32 s65, 0xff800000
    v_cndmask_b32 v107, v10, 0, s[64:65]
    v_cndmask_b32 v123, 0, v10, s[64:65]
    s_mov_b32 s64, 0xff000000
    s_mov_b32 s65, 0xf0000000
    v_cndmask_b32 v108, v10, 0, s[64:65]
    v_cndmask_b32 v124, 0, v10, s[64:65]
    s_mov_b32 s64, 0xfe000000
    s_mov_b32 s65, 0xe0000000
    v_cndmask_b32 v109, v10, 0, s[64:65]
    v_cndmask_b32 v125, 0, v10, s[64:65]
    s_mov_b32 s64, 0xfc000000
    s_mov_b32 s65, 0xc0000000
    v_cndmask_b32 v110, v10, 0, s[64:65]
    v_cndmask_b32 v126, 0, v10, s[64:65]
    s_mov_b32 s64, 0xf8000000
    s_mov_b32 s65, 0x80000000
    v_cndmask_b32 v111, v10, 0, s[64:65]
    v_cndmask_b32 v127, 0, v10, s[64:65]
    s_waitcnt vmcnt(8)
    s_waitcnt lgkmcnt(0)
    ds_add_u32 v245, v247 offset:0
    ds_read_b128 v[160:163], v64 offset:0
    ds_read_b128 v[164:167], v65 offset:0
    ds_read_b128 v[168:171], v66 offset:0
    ds_read_b128 v[172:175], v67 offset:0
    s_add_u32 m0, s57, 131072
    s_add_u32 s54, s54, 128
    buffer_load_dwordx4 v16, s[4:7], s54 offen lds
    buffer_load_dwordx4 v17, s[4:7], s54 offen offset:1024 lds
    buffer_load_dwordx4 v18, s[4:7], s54 offen offset:2048 lds
    buffer_load_dwordx4 v19, s[4:7], s54 offen offset:3072 lds
    s_add_u32 m0, s57, 147456
    s_add_u32 s56, s56, 172032
    buffer_load_dwordx4 v20, s[8:11], s56 offen lds
    buffer_load_dwordx4 v21, s[8:11], s56 offen offset:1024 lds
    buffer_load_dwordx4 v22, s[8:11], s56 offen offset:2048 lds
    buffer_load_dwordx4 v23, s[8:11], s56 offen offset:3072 lds
    s_waitcnt vmcnt(8)
    s_waitcnt lgkmcnt(0)
    ds_add_u32 v245, v247 offset:0
    ds_read_b32 v246, v244 offset:512
    ds_read_b128 v[176:179], v64 offset:32768
    ds_read_b128 v[180:183], v65 offset:32768
    ds_read_b128 v[184:187], v66 offset:32768
    ds_read_b128 v[188:191], v67 offset:32768
    s_waitcnt lgkmcnt(4)
    s_mov_b32 s35, 4286578688
L_cl_64:
    v_cmp_gt_u32 vcc, 1, v246
    s_cbranch_vccz L_cok_65
    ds_read_b32 v246, v244 offset:512
    s_add_u32 s35, s35, 1
    s_waitcnt lgkmcnt(0)
    s_cbranch_scc0 L_cl_64
L_cok_65:
    s_add_u32 m0, s57, 0
    s_add_u32 s54, s54, 128
    buffer_load_dwordx4 v16, s[4:7], s54 offen lds
    buffer_load_dwordx4 v17, s[4:7], s54 offen offset:1024 lds
    buffer_load_dwordx4 v18, s[4:7], s54 offen offset:2048 lds
    buffer_load_dwordx4 v19, s[4:7], s54 offen offset:3072 lds
    s_add_u32 m0, s57, 16384
    s_add_u32 s56, s56, 172032
    buffer_load_dwordx4 v20, s[8:11], s56 offen lds
    buffer_load_dwordx4 v21, s[8:11], s56 offen offset:1024 lds
    buffer_load_dwordx4 v22, s[8:11], s56 offen offset:2048 lds
    buffer_load_dwordx4 v23, s[8:11], s56 offen offset:3072 lds
    s_waitcnt vmcnt(8)
    s_waitcnt lgkmcnt(0)
    ds_add_u32 v245, v247 offset:0
    ds_read_b32 v246, v244 offset:512
    ds_read_b128 v[192:195], v68 offset:0
    ds_read_b128 v[196:199], v69 offset:0
    ds_read_b128 v[200:203], v70 offset:0
    ds_read_b128 v[204:207], v71 offset:0
    s_waitcnt lgkmcnt(4)
    s_mov_b32 s35, 4286578688
L_cl_66:
    v_cmp_gt_u32 vcc, 2, v246
    s_cbranch_vccz L_cok_67
    ds_read_b32 v246, v244 offset:512
    s_add_u32 s35, s35, 1
    s_waitcnt lgkmcnt(0)
    s_cbranch_scc0 L_cl_66
L_cok_67:
    s_add_u32 m0, s57, 32768
    s_add_u32 s54, s54, 128
    buffer_load_dwordx4 v16, s[4:7], s54 offen lds
    buffer_load_dwordx4 v17, s[4:7], s54 offen offset:1024 lds
    buffer_load_dwordx4 v18, s[4:7], s54 offen offset:2048 lds
    buffer_load_dwordx4 v19, s[4:7], s54 offen offset:3072 lds
    s_add_u32 m0, s57, 49152
    s_add_u32 s56, s56, 172032
    buffer_load_dwordx4 v20, s[8:11], s56 offen lds
    buffer_load_dwordx4 v21, s[8:11], s56 offen offset:1024 lds
    buffer_load_dwordx4 v22, s[8:11], s56 offen offset:2048 lds
    buffer_load_dwordx4 v23, s[8:11], s56 offen offset:3072 lds
    s_waitcnt vmcnt(8)
    s_waitcnt lgkmcnt(0)
    ds_add_u32 v245, v247 offset:0
    ds_read_b32 v246, v244 offset:512
    ds_read_b128 v[208:211], v4 offset:0
    ds_read_b128 v[212:215], v5 offset:0
    ds_read_b128 v[216:219], v6 offset:0
    ds_read_b128 v[220:223], v7 offset:0
    s_waitcnt lgkmcnt(4)
    s_mov_b32 s35, 4286578688
L_cl_68:
    v_cmp_gt_u32 vcc, 3, v246
    s_cbranch_vccz L_cok_69
    ds_read_b32 v246, v244 offset:512
    s_add_u32 s35, s35, 1
    s_waitcnt lgkmcnt(0)
    s_cbranch_scc0 L_cl_68
L_cok_69:
    s_add_u32 m0, s58, 65536
    s_nop 0
    buffer_load_dwordx4 v24, s[8:11], s53 offen lds
    buffer_load_dwordx4 v25, s[8:11], s53 offen offset:1024 lds
    s_add_u32 m0, s58, 73728
    s_add_u32 s53, s53, 172032
    buffer_load_dwordx4 v24, s[8:11], s53 offen lds
    buffer_load_dwordx4 v25, s[8:11], s53 offen offset:1024 lds
    s_add_u32 m0, s58, 81920
    s_add_u32 s53, s53, 172032
    buffer_load_dwordx4 v24, s[8:11], s53 offen lds
    buffer_load_dwordx4 v25, s[8:11], s53 offen offset:1024 lds
    s_add_u32 m0, s58, 90112
    s_add_u32 s53, s53, 172032
    buffer_load_dwordx4 v24, s[8:11], s53 offen lds
    s_mov_b64 exec, s[38:39]
    buffer_load_dwordx4 v25, s[8:11], s53 offen offset:1024 lds
    s_mov_b64 exec, -1
    s_waitcnt vmcnt(8)
    s_waitcnt lgkmcnt(0)
    ds_add_u32 v245, v247 offset:0
    ds_read_b32 v246, v244 offset:512
    ds_read_b128 v[224:227], v4 offset:32768
    ds_read_b128 v[228:231], v5 offset:32768
    ds_read_b128 v[232:235], v6 offset:32768
    ds_read_b128 v[236:239], v7 offset:32768
    s_waitcnt lgkmcnt(4)
    s_mov_b32 s35, 4286578688
L_cl_70:
    v_cmp_gt_u32 vcc, 4, v246
    s_cbranch_vccz L_cok_71
    ds_read_b32 v246, v244 offset:512
    s_add_u32 s35, s35, 1
    s_waitcnt lgkmcnt(0)
    s_cbranch_scc0 L_cl_70
L_cok_71:
    s_add_u32 m0, s58, 98304
    s_add_u32 s53, s53, 172032
    buffer_load_dwordx4 v24, s[8:11], s53 offen lds
    buffer_load_dwordx4 v25, s[8:11], s53 offen offset:1024 lds
    s_add_u32 m0, s58, 106496
    s_add_u32 s53, s53, 172032
    buffer_load_dwordx4 v24, s[8:11], s53 offen lds
    buffer_load_dwordx4 v25, s[8:11], s53 offen offset:1024 lds
    s_add_u32 m0, s58, 114688
    s_add_u32 s53, s53, 172032
    buffer_load_dwordx4 v24, s[8:11], s53 offen lds
    buffer_load_dwordx4 v25, s[8:11], s53 offen offset:1024 lds
    s_waitcnt vmcnt(6)
    s_waitcnt lgkmcnt(0)
    ds_add_u32 v245, v247 offset:0
    ds_add_u32 v250, v247 offset:956
    buffer_load_dwordx2 v[240:241], v15, s[24:27], 0 offen sc1
    s_mov_b32 s35, 0
L_spin_72:
    ds_read_b32 v246, v244 offset:0
    s_add_u32 s35, s35, 1
    s_waitcnt lgkmcnt(0)
    v_cmp_gt_u32 vcc, 8, v246
    s_cmp_gt_u32 s35, 8388608
    s_cbranch_scc1 L_spok_73
    s_cbranch_vccnz L_spin_72
L_spok_73:
    ds_read_b64_tr_b16 v[64:65], v8 offset:0
    ds_read_b64_tr_b16 v[66:67], v8 offset:512
    ds_read_b64_tr_b16 v[68:69], v3 offset:0
    ds_read_b64_tr_b16 v[70:71], v3 offset:512
    ds_read_b64_tr_b16 v[72:73], v8 offset:2048
    ds_read_b64_tr_b16 v[74:75], v8 offset:2560
    ds_read_b64_tr_b16 v[76:77], v3 offset:2048
    ds_read_b64_tr_b16 v[78:79], v3 offset:2560
    s_waitcnt lgkmcnt(6)
    v_mfma_f32_32x32x16_bf16 v[32:47], v[64:67], v[128:131], 0
    ds_read_b64_tr_b16 v[80:81], v8 offset:4096
    ds_read_b64_tr_b16 v[82:83], v8 offset:4608
    s_waitcnt lgkmcnt(6)
    v_mfma_f32_32x32x16_bf16 v[48:63], v[68:71], v[128:131], 0
    ds_read_b64_tr_b16 v[84:85], v3 offset:4096
    ds_read_b64_tr_b16 v[86:87], v3 offset:4608
    s_waitcnt lgkmcnt(6)
    v_mfma_f32_32x32x16_bf16 v[32:47], v[72:75], v[132:135], v[32:47]
    ds_read_b64_tr_b16 v[64:65], v8 offset:6144
    ds_read_b64_tr_b16 v[66:67], v8 offset:6656
    s_waitcnt lgkmcnt(6)
    v_mfma_f32_32x32x16_bf16 v[48:63], v[76:79], v[132:135], v[48:63]
    ds_read_b64_tr_b16 v[68:69], v3 offset:6144
    ds_read_b64_tr_b16 v[70:71], v3 offset:6656
    s_waitcnt lgkmcnt(6)
    v_mfma_f32_32x32x16_bf16 v[32:47], v[80:83], v[136:139], v[32:47]
    ds_read_b64_tr_b16 v[72:73], v8 offset:8192
    ds_read_b64_tr_b16 v[74:75], v8 offset:8704
    s_waitcnt lgkmcnt(6)
    v_mfma_f32_32x32x16_bf16 v[48:63], v[84:87], v[136:139], v[48:63]
    ds_read_b64_tr_b16 v[76:77], v3 offset:8192
    ds_read_b64_tr_b16 v[78:79], v3 offset:8704
    s_waitcnt lgkmcnt(6)
    v_mfma_f32_32x32x16_bf16 v[32:47], v[64:67], v[140:143], v[32:47]
    ds_read_b64_tr_b16 v[80:81], v8 offset:10240
    ds_read_b64_tr_b16 v[82:83], v8 offset:10752
    s_waitcnt lgkmcnt(6)
    v_mfma_f32_32x32x16_bf16 v[48:63], v[68:71], v[140:143], v[48:63]
    ds_read_b64_tr_b16 v[84:85], v3 offset:10240
    ds_read_b64_tr_b16 v[86:87], v3 offset:10752
    s_waitcnt lgkmcnt(6)
    v_mfma_f32_32x32x16_bf16 v[32:47], v[72:75], v[144:147], v[32:47]
    ds_read_b64_tr_b16 v[64:65], v8 offset:12288
    ds_read_b64_tr_b16 v[66:67], v8 offset:12800
    s_waitcnt lgkmcnt(6)
    v_mfma_f32_32x32x16_bf16 v[48:63], v[76:79], v[144:147], v[48:63]
    ds_read_b64_tr_b16 v[68:69], v3 offset:12288
    ds_read_b64_tr_b16 v[70:71], v3 offset:12800
    s_waitcnt lgkmcnt(6)
    v_mfma_f32_32x32x16_bf16 v[32:47], v[80:83], v[148:151], v[32:47]
    ds_read_b64_tr_b16 v[72:73], v8 offset:14336
    ds_read_b64_tr_b16 v[74:75], v8 offset:14848
    s_waitcnt lgkmcnt(6)
    v_mfma_f32_32x32x16_bf16 v[48:63], v[84:87], v[148:151], v[48:63]
    ds_read_b64_tr_b16 v[76:77], v3 offset:14336
    ds_read_b64_tr_b16 v[78:79], v3 offset:14848
    s_waitcnt lgkmcnt(6)
    v_mfma_f32_32x32x16_bf16 v[32:47], v[64:67], v[152:155], v[32:47]
    ds_read_b64_tr_b16 v[80:81], v8 offset:16384
    ds_read_b64_tr_b16 v[82:83], v8 offset:16896
    s_waitcnt lgkmcnt(6)
    v_mfma_f32_32x32x16_bf16 v[48:63], v[68:71], v[152:155], v[48:63]
    ds_read_b64_tr_b16 v[84:85], v3 offset:16384
    ds_read_b64_tr_b16 v[86:87], v3 offset:16896
    s_waitcnt lgkmcnt(6)
    v_mfma_f32_32x32x16_bf16 v[32:47], v[72:75], v[156:159], v[32:47]
    ds_read_b64_tr_b16 v[64:65], v8 offset:18432
    ds_read_b64_tr_b16 v[66:67], v8 offset:18944
    s_waitcnt lgkmcnt(6)
    v_mfma_f32_32x32x16_bf16 v[48:63], v[76:79], v[156:159], v[48:63]
    ds_read_b64_tr_b16 v[68:69], v3 offset:18432
    ds_read_b64_tr_b16 v[70:71], v3 offset:18944
    s_waitcnt lgkmcnt(6)
    v_mfma_f32_32x32x16_bf16 v[32:47], v[80:83], v[160:163], v[32:47]
    ds_read_b64_tr_b16 v[72:73], v8 offset:20480
    ds_read_b64_tr_b16 v[74:75], v8 offset:20992
    s_waitcnt lgkmcnt(6)
    v_mfma_f32_32x32x16_bf16 v[48:63], v[84:87], v[160:163], v[48:63]
    ds_read_b64_tr_b16 v[76:77], v3 offset:20480
    ds_read_b64_tr_b16 v[78:79], v3 offset:20992
    s_waitcnt lgkmcnt(6)
    v_mfma_f32_32x32x16_bf16 v[32:47], v[64:67], v[164:167], v[32:47]
    ds_read_b64_tr_b16 v[80:81], v8 offset:22528
    ds_read_b64_tr_b16 v[82:83], v8 offset:23040
    s_waitcnt lgkmcnt(6)
    v_mfma_f32_32x32x16_bf16 v[48:63], v[68:71], v[164:167], v[48:63]
    ds_read_b64_tr_b16 v[84:85], v3 offset:22528
    ds_read_b64_tr_b16 v[86:87], v3 offset:23040
    s_waitcnt vmcnt(1)
    ds_add_u32 v245, v247 offset:0
    s_waitcnt lgkmcnt(7)
    v_mfma_f32_32x32x16_bf16 v[32:47], v[72:75], v[168:171], v[32:47]
    ds_read_b64_tr_b16 v[64:65], v8 offset:24576
    ds_read_b64_tr_b16 v[66:67], v8 offset:25088
    s_waitcnt lgkmcnt(7)
    v_mfma_f32_32x32x16_bf16 v[48:63], v[76:79], v[168:171], v[48:63]
    ds_read_b64_tr_b16 v[68:69], v3 offset:24576
    ds_read_b64_tr_b16 v[70:71], v3 offset:25088
    s_waitcnt lgkmcnt(7)
    v_mfma_f32_32x32x16_bf16 v[32:47], v[80:83], v[172:175], v[32:47]
    ds_read_b64_tr_b16 v[72:73], v8 offset:26624
    ds_read_b64_tr_b16 v[74:75], v8 offset:27136
    s_waitcnt lgkmcnt(7)
    v_mfma_f32_32x32x16_bf16 v[48:63], v[84:87], v[172:175], v[48:63]
    ds_read_b64_tr_b16 v[76:77], v3 offset:26624
    ds_read_b64_tr_b16 v[78:79], v3 offset:27136
    s_waitcnt lgkmcnt(6)
    v_mfma_f32_32x32x16_bf16 v[32:47], v[64:67], v[176:179], v[32:47]
    ds_read_b64_tr_b16 v[80:81], v8 offset:28672
    ds_read_b64_tr_b16 v[82:83], v8 offset:29184
    s_waitcnt lgkmcnt(6)
    v_mfma_f32_32x32x16_bf16 v[48:63], v[68:71], v[176:179], v[48:63]
    ds_read_b64_tr_b16 v[84:85], v3 offset:28672
    ds_read_b64_tr_b16 v[86:87], v3 offset:29184
    s_waitcnt lgkmcnt(6)
    v_mfma_f32_32x32x16_bf16 v[32:47], v[72:75], v[180:183], v[32:47]
    ds_read_b32 v246, v244
    ds_read_b64_tr_b16 v[64:65], v8 offset:30720
    ds_read_b64_tr_b16 v[66:67], v8 offset:31232
    s_waitcnt lgkmcnt(7)
    v_mfma_f32_32x32x16_bf16 v[48:63], v[76:79], v[180:183], v[48:63]
    ds_read_b64_tr_b16 v[68:69], v3 offset:30720
    ds_read_b64_tr_b16 v[70:71], v3 offset:31232
    s_waitcnt lgkmcnt(7)
    v_mfma_f32_32x32x16_bf16 v[32:47], v[80:83], v[184:187], v[32:47]
    s_waitcnt lgkmcnt(4)
    s_mov_b32 s35, 4286578688
L_cl_74:
    v_cmp_gt_u32 vcc, 9, v246
    s_cbranch_vccz L_cok_75
    ds_read_b32 v246, v244 offset:0
    s_add_u32 s35, s35, 1
    s_waitcnt lgkmcnt(0)
    s_cbranch_scc0 L_cl_74
L_cok_75:
    ds_read_b64_tr_b16 v[72:73], v8 offset:32768
    ds_read_b64_tr_b16 v[74:75], v8 offset:33280
    v_mfma_f32_32x32x16_bf16 v[48:63], v[84:87], v[184:187], v[48:63]
    ds_read_b64_tr_b16 v[76:77], v3 offset:32768
    ds_read_b64_tr_b16 v[78:79], v3 offset:33280
    s_waitcnt lgkmcnt(6)
    v_mfma_f32_32x32x16_bf16 v[32:47], v[64:67], v[188:191], v[32:47]
    ds_read_b64_tr_b16 v[80:81], v8 offset:34816
    ds_read_b64_tr_b16 v[82:83], v8 offset:35328
    s_waitcnt lgkmcnt(6)
    v_mfma_f32_32x32x16_bf16 v[48:63], v[68:71], v[188:191], v[48:63]
    ds_read_b64_tr_b16 v[84:85], v3 offset:34816
    ds_read_b64_tr_b16 v[86:87], v3 offset:35328
    s_waitcnt lgkmcnt(6)
    v_mfma_f32_32x32x16_bf16 v[32:47], v[72:75], v[192:195], v[32:47]
    ds_read_b64_tr_b16 v[64:65], v8 offset:36864
    ds_read_b64_tr_b16 v[66:67], v8 offset:37376
    s_lshl_b32 s62, s51, 14
    s_lshl_b32 s63, s50, 12
    s_waitcnt lgkmcnt(6)
    v_mfma_f32_32x32x16_bf16 v[48:63], v[76:79], v[192:195], v[48:63]
    ds_read_b64_tr_b16 v[68:69], v3 offset:36864
    ds_read_b64_tr_b16 v[70:71], v3 offset:37376
    s_add_u32 s62, s62, s63
    s_add_u32 s62, s62, 131072
    v_add_u32 v176, s62, v9
    s_waitcnt lgkmcnt(6)
    v_mfma_f32_32x32x16_bf16 v[32:47], v[80:83], v[196:199], v[32:47]
    ds_read_b64_tr_b16 v[72:73], v8 offset:38912
    ds_read_b64_tr_b16 v[74:75], v8 offset:39424
    s_mov_b32 s63, 0xfffeb000
    s_cmp_eq_u32 s50, 0
    s_cselect_b32 s62, s63, 0xfffff000
    v_add_u32 v177, s62, v176
    s_waitcnt lgkmcnt(6)
    v_mfma_f32_32x32x16_bf16 v[48:63], v[84:87], v[196:199], v[48:63]
    ds_read_b64_tr_b16 v[76:77], v3 offset:38912
    ds_read_b64_tr_b16 v[78:79], v3 offset:39424
    s_mov_b32 s63, 0xfffeb000
    s_cmp_eq_u32 s50, 1
    s_cselect_b32 s62, s63, 0xfffff000
    v_add_u32 v178, s62, v177
    s_waitcnt lgkmcnt(6)
    v_mfma_f32_32x32x16_bf16 v[32:47], v[64:67], v[200:203], v[32:47]
    ds_read_b64_tr_b16 v[80:81], v8 offset:40960
    ds_read_b64_tr_b16 v[82:83], v8 offset:41472
    s_mov_b32 s63, 0xfffeb000
    s_cmp_eq_u32 s50, 2
    s_cselect_b32 s62, s63, 0xfffff000
    v_add_u32 v179, s62, v178
    s_waitcnt lgkmcnt(6)
    v_mfma_f32_32x32x16_bf16 v[48:63], v[68:71], v[200:203], v[48:63]
    ds_read_b64_tr_b16 v[84:85], v3 offset:40960
    ds_read_b64_tr_b16 v[86:87], v3 offset:41472
    s_mov_b32 s63, 0xfffeb000
    s_cmp_eq_u32 s50, 3
    s_cselect_b32 s62, s63, 0xfffff000
    v_add_u32 v180, s62, v179
    s_waitcnt lgkmcnt(6)
    v_mfma_f32_32x32x16_bf16 v[32:47], v[72:75], v[204:207], v[32:47]
    ds_read_b64_tr_b16 v[64:65], v8 offset:43008
    ds_read_b64_tr_b16 v[66:67], v8 offset:43520
    s_mov_b32 s63, 0xffffb000
    s_cmp_eq_u32 s50, 0
    s_cselect_b32 s62, s63, 0xfffff000
    v_add_u32 v181, s62, v180
    s_waitcnt lgkmcnt(6)
    v_mfma_f32_32x32x16_bf16 v[48:63], v[76:79], v[204:207], v[48:63]
    ds_read_b64_tr_b16 v[68:69], v3 offset:43008
    ds_read_b64_tr_b16 v[70:71], v3 offset:43520
    s_mov_b32 s63, 0xffffb000
    s_cmp_eq_u32 s50, 1
    s_cselect_b32 s62, s63, 0xfffff000
    v_add_u32 v182, s62, v181
    s_waitcnt lgkmcnt(6)
    v_mfma_f32_32x32x16_bf16 v[32:47], v[80:83], v[208:211], v[32:47]
    ds_read_b64_tr_b16 v[72:73], v8 offset:45056
    ds_read_b64_tr_b16 v[74:75], v8 offset:45568
    s_mov_b32 s63, 0xffffb000
    s_cmp_eq_u32 s50, 2
    s_cselect_b32 s62, s63, 0xfffff000
    v_add_u32 v183, s62, v182
    s_waitcnt lgkmcnt(6)
    v_mfma_f32_32x32x16_bf16 v[48:63], v[84:87], v[208:211], v[48:63]
    ds_read_b64_tr_b16 v[76:77], v3 offset:45056
    ds_read_b64_tr_b16 v[78:79], v3 offset:45568
    s_mov_b32 s63, 0xffffb000
    s_cmp_eq_u32 s50, 3
    s_cselect_b32 s62, s63, 0xfffff000
    v_add_u32 v184, s62, v183
    s_waitcnt lgkmcnt(6)
    v_mfma_f32_32x32x16_bf16 v[32:47], v[64:67], v[212:215], v[32:47]
    ds_read_b64_tr_b16 v[80:81], v8 offset:47104
    ds_read_b64_tr_b16 v[82:83], v8 offset:47616
    v_lshrrev_b32 v10, 4, v1
    v_lshlrev_b32 v11, 2, v10
    s_waitcnt lgkmcnt(6)
    v_mfma_f32_32x32x16_bf16 v[48:63], v[68:71], v[212:215], v[48:63]
    ds_read_b64_tr_b16 v[84:85], v3 offset:47104
    ds_read_b64_tr_b16 v[86:87], v3 offset:47616
    v_and_b32 v12, 15, v1
    v_xor_b32 v11, v11, v12
    s_waitcnt lgkmcnt(6)
    v_mfma_f32_32x32x16_bf16 v[32:47], v[72:75], v[216:219], v[32:47]
    ds_read_b64_tr_b16 v[64:65], v8 offset:49152
    ds_read_b64_tr_b16 v[66:67], v8 offset:49664
    v_mul_u32_u24 v248, 896, v10
    v_lshl_add_u32 v248, v11, 4, v248
    s_waitcnt lgkmcnt(6)
    v_mfma_f32_32x32x16_bf16 v[48:63], v[76:79], v[216:219], v[48:63]
    ds_read_b64_tr_b16 v[68:69], v3 offset:49152
    ds_read_b64_tr_b16 v[70:71], v3 offset:49664
    s_cmp_eq_u32 s32, 3
    s_cselect_b32 s62, 8, 64
    v_mov_b32 v12, 0x7ff00000
    s_waitcnt lgkmcnt(6)
    v_mfma_f32_32x32x16_bf16 v[32:47], v[80:83], v[220:223], v[32:47]
    ds_read_b64_tr_b16 v[72:73], v8 offset:51200
    ds_read_b64_tr_b16 v[74:75], v8 offset:51712
    v_cmp_le_u32 vcc, s62, v11
    s_lshl_b32 s63, s51, 7
    v_add_u32 v251, s63, v249
    v_cndmask_b32 v248, v248, v12, vcc
    s_waitcnt lgkmcnt(6)
    v_mfma_f32_32x32x16_bf16 v[48:63], v[84:87], v[220:223], v[48:63]
    ds_read_b64_tr_b16 v[76:77], v3 offset:51200
    ds_read_b64_tr_b16 v[78:79], v3 offset:51712
    s_waitcnt lgkmcnt(6)
    v_mfma_f32_32x32x16_bf16 v[32:47], v[64:67], v[224:227], v[32:47]
    ds_read_b64_tr_b16 v[80:81], v8 offset:53248
    ds_read_b64_tr_b16 v[82:83], v8 offset:53760
    s_waitcnt lgkmcnt(6)
    v_mfma_f32_32x32x16_bf16 v[48:63], v[68:71], v[224:227], v[48:63]
    ds_read_b64_tr_b16 v[84:85], v3 offset:53248
    ds_read_b64_tr_b16 v[86:87], v3 offset:53760
    s_waitcnt lgkmcnt(6)
    v_mfma_f32_32x32x16_bf16 v[32:47], v[72:75], v[228:231], v[32:47]
    ds_read_b64_tr_b16 v[64:65], v8 offset:55296
    ds_read_b64_tr_b16 v[66:67], v8 offset:55808
    s_waitcnt lgkmcnt(6)
    v_mfma_f32_32x32x16_bf16 v[48:63], v[76:79], v[228:231], v[48:63]
    ds_read_b64_tr_b16 v[68:69], v3 offset:55296
    ds_read_b64_tr_b16 v[70:71], v3 offset:55808
    s_waitcnt lgkmcnt(6)
    v_mfma_f32_32x32x16_bf16 v[32:47], v[80:83], v[232:235], v[32:47]
    s_waitcnt lgkmcnt(4)
    v_mfma_f32_32x32x16_bf16 v[48:63], v[84:87], v[232:235], v[48:63]
    s_waitcnt lgkmcnt(2)
    v_mfma_f32_32x32x16_bf16 v[32:47], v[64:67], v[236:239], v[32:47]
    s_waitcnt lgkmcnt(0)
    v_mfma_f32_32x32x16_bf16 v[48:63], v[68:71], v[236:239], v[48:63]
    v_mov_b32 v11, s66
    v_cndmask_b32 v12, v11, 0, s[68:69]
    s_lshl_b32 s62, s55, 11
    s_add_u32 s62, s62, 122880
    v_add_u32 v10, s62, v9
    s_nop 5
    v_cvt_pk_bf16_f32 v33, v32, v33
    v_lshlrev_b32 v32, 16, v33
    v_and_b32 v33, 0xffff0000, v33
    v_cvt_pk_bf16_f32 v35, v34, v35
    v_lshlrev_b32 v34, 16, v35
    v_and_b32 v35, 0xffff0000, v35
    v_cvt_pk_bf16_f32 v37, v36, v37
    v_lshlrev_b32 v36, 16, v37
    v_and_b32 v37, 0xffff0000, v37
    v_cvt_pk_bf16_f32 v39, v38, v39
    v_lshlrev_b32 v38, 16, v39
    v_and_b32 v39, 0xffff0000, v39
    v_cvt_pk_bf16_f32 v41, v40, v41
    v_lshlrev_b32 v40, 16, v41
    v_and_b32 v41, 0xffff0000, v41
    v_cvt_pk_bf16_f32 v43, v42, v43
    v_lshlrev_b32 v42, 16, v43
    v_and_b32 v43, 0xffff0000, v43
    v_cvt_pk_bf16_f32 v45, v44, v45
    v_lshlrev_b32 v44, 16, v45
    v_and_b32 v45, 0xffff0000, v45
    v_cvt_pk_bf16_f32 v47, v46, v47
    v_lshlrev_b32 v46, 16, v47
    v_and_b32 v47, 0xffff0000, v47
    v_mul_f32 v32, v11, v32
    v_mul_f32 v33, v11, v33
    v_mul_f32 v34, v11, v34
    v_mul_f32 v35, v11, v35
    v_mul_f32 v36, v11, v36
    v_mul_f32 v37, v11, v37
    v_mul_f32 v38, v11, v38
    v_mul_f32 v39, v11, v39
    v_mul_f32 v40, v11, v40
    v_mul_f32 v41, v11, v41
    v_mul_f32 v42, v11, v42
    v_mul_f32 v43, v11, v43
    v_mul_f32 v44, v12, v44
    v_mul_f32 v45, v12, v45
    v_mul_f32 v46, v12, v46
    v_mul_f32 v47, v12, v47
    v_cvt_pk_bf16_f32 v32, v32, v33
    v_cvt_pk_bf16_f32 v33, v34, v35
    v_cvt_pk_bf16_f32 v34, v36, v37
    v_cvt_pk_bf16_f32 v35, v38, v39
    v_cvt_pk_bf16_f32 v36, v40, v41
    v_cvt_pk_bf16_f32 v37, v42, v43
    v_cvt_pk_bf16_f32 v38, v44, v45
    v_cvt_pk_bf16_f32 v39, v46, v47
    ds_write_b128 v10, v[32:35] offset:0
    ds_write_b128 v10, v[36:39] offset:1024
    s_waitcnt lgkmcnt(0)
    ds_add_u32 v250, v247 offset:764
    v_cvt_pk_bf16_f32 v49, v48, v49
    v_lshlrev_b32 v48, 16, v49
    v_and_b32 v49, 0xffff0000, v49
    v_cvt_pk_bf16_f32 v51, v50, v51
    v_lshlrev_b32 v50, 16, v51
    v_and_b32 v51, 0xffff0000, v51
    v_cvt_pk_bf16_f32 v53, v52, v53
    v_lshlrev_b32 v52, 16, v53
    v_and_b32 v53, 0xffff0000, v53
    v_cvt_pk_bf16_f32 v55, v54, v55
    v_lshlrev_b32 v54, 16, v55
    v_and_b32 v55, 0xffff0000, v55
    v_cvt_pk_bf16_f32 v57, v56, v57
    v_lshlrev_b32 v56, 16, v57
    v_and_b32 v57, 0xffff0000, v57
    v_cvt_pk_bf16_f32 v59, v58, v59
    v_lshlrev_b32 v58, 16, v59
    v_and_b32 v59, 0xffff0000, v59
    v_cvt_pk_bf16_f32 v61, v60, v61
    v_lshlrev_b32 v60, 16, v61
    v_and_b32 v61, 0xffff0000, v61
    v_cvt_pk_bf16_f32 v63, v62, v63
    v_lshlrev_b32 v62, 16, v63
    v_and_b32 v63, 0xffff0000, v63
    v_mul_f32 v48, v11, v48
    v_mul_f32 v49, v11, v49
    v_mul_f32 v50, v11, v50
    v_mul_f32 v51, v11, v51
    v_mul_f32 v52, v11, v52
    v_mul_f32 v53, v11, v53
    v_mul_f32 v54, v11, v54
    v_mul_f32 v55, v11, v55
    v_mul_f32 v56, v11, v56
    v_mul_f32 v57, v11, v57
    v_mul_f32 v58, v11, v58
    v_mul_f32 v59, v11, v59
    v_mul_f32 v60, v12, v60
    v_mul_f32 v61, v12, v61
    v_mul_f32 v62, v12, v62
    v_mul_f32 v63, v12, v63
    v_cvt_pk_bf16_f32 v16, v48, v49
    v_cvt_pk_bf16_f32 v17, v50, v51
    v_cvt_pk_bf16_f32 v18, v52, v53
    v_cvt_pk_bf16_f32 v19, v54, v55
    v_cvt_pk_bf16_f32 v20, v56, v57
    v_cvt_pk_bf16_f32 v21, v58, v59
    v_cvt_pk_bf16_f32 v22, v60, v61
    v_cvt_pk_bf16_f32 v23, v62, v63
    s_waitcnt vmcnt(0)
    s_mov_b32 s35, 0
L_nlp_76:
    v_readfirstlane_b32 s60, v240
    v_readfirstlane_b32 s61, v241
    s_add_u32 s35, s35, 1
    s_cmp_lg_u32 s60, 0
    s_cbranch_scc1 L_nok_77
    s_cmp_gt_u32 s35, 1048576
    s_cbranch_scc1 L_nok_77
    buffer_load_dwordx2 v[240:241], v15, s[24:27], 0 offen sc1
    s_waitcnt vmcnt(0)
    s_branch L_nlp_76
L_nok_77:
    s_and_b32 s62, s30, 3
    s_mul_i32 s62, s62, 100352
    s_lshl_b32 s63, s32, 8
    s_add_u32 s62, s62, s63
    s_and_b32 s63, s55, 1
    s_lshl_b32 s63, s63, 7
    s_add_u32 s62, s62, s63
    s_lshr_b32 s63, s55, 1
    s_mul_i32 s63, s63, 50176
    s_add_u32 s62, s62, s63
    v_mul_u32_u24 v10, 896, v1
    s_mov_b32 s64, 0xffffffff
    s_mov_b32 s65, 0x00ffffff
    s_mov_b64 exec, s[64:65]
    buffer_load_dword v255, v10, s[12:15], s62 offen
    s_mov_b64 exec, -1
    s_mov_b32 s35, 0
L_spin_78:
    ds_read_b32 v246, v249 offset:636
    s_add_u32 s35, s35, 1
    s_waitcnt lgkmcnt(0)
    v_cmp_gt_u32 vcc, 4, v246
    s_cmp_gt_u32 s35, 8388608
    s_cbranch_scc1 L_spok_79
    s_cbranch_vccnz L_spin_78
L_spok_79:
    s_branch L_xA
L_consA:
    s_mov_b32 s24, s46
    s_mov_b32 s25, s47
    s_mov_b32 s26, 256
    s_mov_b32 s27, 0x20000
    v_mov_b32 v15, 0
    v_lshlrev_b32 v9, 4, v1
    s_or_b32 s62, s2, s31
    s_cmp_lg_u32 s62, 0
    s_cbranch_scc1 L_non_80
    s_memrealtime s[60:61]
    s_waitcnt lgkmcnt(0)
    s_or_b32 s60, s60, 1
    v_mov_b32 v240, s60
    v_mov_b32 v241, s61
    s_mov_b64 exec, 1
    buffer_store_dwordx2 v[240:241], v15, s[24:27], 0 offen sc1
    s_mov_b64 exec, -1
L_non_80:
    s_and_b32 s64, s31, 1
    s_lshl_b32 s64, s64, 13
    v_and_b32 v10, 31, v1
    v_bfe_u32 v11, v1, 1, 3
    v_lshrrev_b32 v12, 5, v1
    v_xor_b32 v11, v11, v12
    v_lshlrev_b32 v10, 7, v10
    v_add_u32 v10, s64, v10
    v_lshl_add_u32 v4, v11, 4, v10
    v_xor_b32 v5, 32, v4
    v_xor_b32 v6, 64, v4
    v_xor_b32 v7, 96, v4
    s_lshr_b32 s65, s31, 1
    s_mul_i32 s63, s65, 56
    v_bfe_u32 v10, v1, 2, 2
    v_lshrrev_b32 v12, 5, v1
    v_lshl_add_u32 v11, v12, 3, v10
    v_lshlrev_b32 v11, 7, v11
    v_lshrrev_b32 v10, 1, v10
    v_lshlrev_b32 v10, 6, v10
    v_and_b32 v12, 3, v1
    v_lshlrev_b32 v12, 3, v12
    v_and_b32 v8, 16, v1
    v_lshl_add_u32 v12, v8, 1, v12
    v_add_u32 v12, s63, v12
    v_xor_b32 v12, v12, v10
    v_add_u32 v8, v11, v12
    v_add_u32 v16, 0x0, v4
    v_add_u32 v17, 0x0, v5
    v_add_u32 v18, 0x0, v6
    v_add_u32 v19, 0x0, v7
    v_add_u32 v20, 0x0, v8
    v_add_u32 v21, 0x10000, v4
    v_add_u32 v22, 0x10000, v5
    v_add_u32 v23, 0x10000, v6
    v_add_u32 v24, 0x10000, v7
    v_add_u32 v25, 0x10000, v8
    v_add_u32 v26, 0x20000, v4
    v_add_u32 v27, 0x20000, v5
    v_add_u32 v28, 0x20000, v6
    v_add_u32 v29, 0x20000, v7
    v_add_u32 v30, 0x20000, v8
    s_lshl_b32 s67, s31, 13
    s_add_u32 s62, s67, 131072
    v_add_u32 v2, s62, v9
    s_cmp_eq_u32 s28, 0
    s_cselect_b32 s12, s36, s42
    s_cselect_b32 s13, s37, s43
    s_mov_b32 s14, 0x62000
    s_mov_b32 s15, 0x20000
    s_mov_b32 s16, s48
    s_mov_b32 s17, s49
    s_mov_b32 s18, 0x2400000
    s_mov_b32 s19, 0x20000
    s_mov_b32 s20, s44
    s_mov_b32 s21, s45
    s_mov_b32 s22, 0x380000
    s_mov_b32 s23, 0x20000
    s_mov_b32 s68, 0
    s_mov_b32 s69, -1
    s_mov_b32 s66, 0x3e8b97f6
    s_lshl_b32 s52, s31, 10
    s_lshr_b32 s51, s31, 2
    s_sub_u32 s63, 3, s55
    s_cmp_lt_u32 s31, 4
    s_cselect_b32 s50, s63, s55
    s_lshl_b32 s59, s28, 3
    s_add_u32 s59, s59, s29
    s_lshl_b32 s59, s59, 4
    s_add_u32 s59, s59, s30
    s_mul_i32 s37, s59, 33280
    s_lshl_b32 s59, s59, 15
    s_and_b32 s32, s29, 3
    s_lshr_b32 s62, s29, 2
    s_lshl_b32 s33, s30, 1
    s_add_u32 s33, s33, s62
    s_mul_i32 s34, s31, 3584
    s_lshl_b32 s62, s32, 8
    s_add_u32 s34, s34, s62
    s_mov_b32 s35, 0
L_spin_81:
    ds_read_b32 v246, v244 offset:0
    s_add_u32 s35, s35, 1
    s_waitcnt lgkmcnt(0)
    v_cmp_gt_u32 vcc, 1, v246
    s_cmp_gt_u32 s35, 8388608
    s_cbranch_scc1 L_spok_82
    s_cbranch_vccnz L_spin_81
L_spok_82:
    ds_read_b128 v[128:131], v16 offset:0
    ds_read_b64_tr_b16 v[152:153], v20 offset:16384
    ds_read_b64_tr_b16 v[154:155], v20 offset:16896
    ds_read_b128 v[132:135], v16 offset:4096
    ds_read_b64_tr_b16 v[156:157], v20 offset:18432
    ds_read_b64_tr_b16 v[158:159], v20 offset:18944
    ds_read_b128 v[136:139], v17 offset:0
    ds_read_b64_tr_b16 v[160:161], v20 offset:20480
    ds_read_b64_tr_b16 v[162:163], v20 offset:20992
    ds_read_b128 v[140:143], v17 offset:4096
    ds_read_b64_tr_b16 v[164:165], v20 offset:22528
    ds_read_b64_tr_b16 v[166:167], v20 offset:23040
    s_waitcnt lgkmcnt(9)
    v_mfma_f32_32x32x16_bf16 v[32:47], v[152:155], v[128:131], 0
    ds_read_b128 v[144:147], v18 offset:0
    ds_read_b64_tr_b16 v[168:169], v20 offset:24576
    s_waitcnt lgkmcnt(10)
    v_mfma_f32_32x32x16_bf16 v[48:63], v[152:155], v[132:135], 0
    ds_read_b64_tr_b16 v[170:171], v20 offset:25088
    s_waitcnt lgkmcnt(9)
    v_mfma_f32_32x32x16_bf16 v[64:79], v[128:131], v[156:159], 0
    ds_read_b128 v[148:151], v18 offset:4096
    ds_read_b64_tr_b16 v[172:173], v20 offset:26624
    v_mfma_f32_32x32x16_bf16 v[80:95], v[132:135], v[156:159], 0
    ds_read_b64_tr_b16 v[174:175], v20 offset:27136
    s_waitcnt lgkmcnt(9)
    v_mfma_f32_32x32x16_bf16 v[32:47], v[160:163], v[136:139], v[32:47]
    ds_read_b128 v[128:131], v19 offset:0
    ds_read_b64_tr_b16 v[152:153], v20 offset:28672
    s_waitcnt lgkmcnt(10)
    v_mfma_f32_32x32x16_bf16 v[48:63], v[160:163], v[140:143], v[48:63]
    ds_read_b64_tr_b16 v[154:155], v20 offset:29184
    ds_read_b32 v246, v244
    s_waitcnt lgkmcnt(10)
    v_mfma_f32_32x32x16_bf16 v[64:79], v[136:139], v[164:167], v[64:79]
    ds_read_b128 v[132:135], v19 offset:4096
    ds_read_b64_tr_b16 v[156:157], v20 offset:30720
    v_mfma_f32_32x32x16_bf16 v[80:95], v[140:143], v[164:167], v[80:95]
    ds_read_b64_tr_b16 v[158:159], v20 offset:31232
    s_waitcnt lgkmcnt(10)
    v_mfma_f32_32x32x16_bf16 v[32:47], v[168:171], v[144:147], v[32:47]
    s_waitcnt lgkmcnt(3)
    s_mov_b32 s35, 4286578688
L_cl_83:
    v_cmp_gt_u32 vcc, 2, v246
    s_cbranch_vccz L_cok_84
    ds_read_b32 v246, v244 offset:0
    s_add_u32 s35, s35, 1
    s_waitcnt lgkmcnt(0)
    s_cbranch_scc0 L_cl_83
L_cok_84:
    ds_read_b128 v[136:139], v16 offset:32768
    ds_read_b64_tr_b16 v[160:161], v20 offset:49152
    v_mfma_f32_32x32x16_bf16 v[48:63], v[168:171], v[148:151], v[48:63]
    ds_read_b64_tr_b16 v[162:163], v20 offset:49664
    v_mfma_f32_32x32x16_bf16 v[64:79], v[144:147], v[172:175], v[64:79]
    ds_read_b128 v[140:143], v16 offset:36864
    ds_read_b64_tr_b16 v[164:165], v20 offset:51200
    v_mfma_f32_32x32x16_bf16 v[80:95], v[148:151], v[172:175], v[80:95]
    ds_read_b64_tr_b16 v[166:167], v20 offset:51712
    v_mfma_f32_32x32x16_bf16 v[32:47], v[152:155], v[128:131], v[32:47]
    ds_read_b128 v[144:147], v17 offset:32768
    ds_read_b64_tr_b16 v[168:169], v20 offset:53248
    s_waitcnt lgkmcnt(10)
    v_mfma_f32_32x32x16_bf16 v[48:63], v[152:155], v[132:135], v[48:63]
    ds_read_b64_tr_b16 v[170:171], v20 offset:53760
    s_waitcnt lgkmcnt(9)
    v_mfma_f32_32x32x16_bf16 v[64:79], v[128:131], v[156:159], v[64:79]
    ds_read_b128 v[148:151], v17 offset:36864
    ds_read_b64_tr_b16 v[172:173], v20 offset:55296
    v_mfma_f32_32x32x16_bf16 v[80:95], v[132:135], v[156:159], v[80:95]
    ds_read_b64_tr_b16 v[174:175], v20 offset:55808
    ds_add_u32 v245, v247 offset:0
    s_waitcnt lgkmcnt(10)
    v_mfma_f32_32x32x16_bf16 v[32:47], v[160:163], v[136:139], v[32:47]
    ds_read_b128 v[128:131], v18 offset:32768
    ds_read_b64_tr_b16 v[152:153], v20 offset:57344
    s_waitcnt lgkmcnt(11)
    v_mfma_f32_32x32x16_bf16 v[48:63], v[160:163], v[140:143], v[48:63]
    ds_read_b64_tr_b16 v[154:155], v20 offset:57856
    s_waitcnt lgkmcnt(10)
    v_mfma_f32_32x32x16_bf16 v[64:79], v[136:139], v[164:167], v[64:79]
    ds_read_b128 v[132:135], v18 offset:36864
    ds_read_b64_tr_b16 v[156:157], v20 offset:59392
    v_mfma_f32_32x32x16_bf16 v[80:95], v[140:143], v[164:167], v[80:95]
    ds_read_b64_tr_b16 v[158:159], v20 offset:59904
    s_waitcnt lgkmcnt(10)
    v_mfma_f32_32x32x16_bf16 v[32:47], v[168:171], v[144:147], v[32:47]
    ds_read_b128 v[136:139], v19 offset:32768
    ds_read_b64_tr_b16 v[160:161], v20 offset:61440
    s_waitcnt lgkmcnt(11)
    v_mfma_f32_32x32x16_bf16 v[48:63], v[168:171], v[148:151], v[48:63]
    ds_read_b64_tr_b16 v[162:163], v20 offset:61952
    ds_read_b32 v246, v244
    s_waitcnt lgkmcnt(11)
    v_mfma_f32_32x32x16_bf16 v[64:79], v[144:147], v[172:175], v[64:79]
    ds_read_b128 v[140:143], v19 offset:36864
    ds_read_b64_tr_b16 v[164:165], v20 offset:63488
    v_mfma_f32_32x32x16_bf16 v[80:95], v[148:151], v[172:175], v[80:95]
    ds_read_b64_tr_b16 v[166:167], v20 offset:64000
    s_waitcnt lgkmcnt(10)
    v_mfma_f32_32x32x16_bf16 v[32:47], v[152:155], v[128:131], v[32:47]
    s_waitcnt lgkmcnt(3)
    s_mov_b32 s35, 4286578688
L_cl_85:
    v_cmp_gt_u32 vcc, 3, v246
    s_cbranch_vccz L_cok_86
    ds_read_b32 v246, v244 offset:0
    s_add_u32 s35, s35, 1
    s_waitcnt lgkmcnt(0)
    s_cbranch_scc0 L_cl_85
L_cok_86:
    ds_read_b128 v[144:147], v21 offset:0
    ds_read_b64_tr_b16 v[168:169], v25 offset:16384
    v_mfma_f32_32x32x16_bf16 v[48:63], v[152:155], v[132:135], v[48:63]
    ds_read_b64_tr_b16 v[170:171], v25 offset:16896
    v_mfma_f32_32x32x16_bf16 v[64:79], v[128:131], v[156:159], v[64:79]
    ds_read_b128 v[148:151], v21 offset:4096
    ds_read_b64_tr_b16 v[172:173], v25 offset:18432
    v_mfma_f32_32x32x16_bf16 v[80:95], v[132:135], v[156:159], v[80:95]
    ds_read_b64_tr_b16 v[174:175], v25 offset:18944
    v_mfma_f32_32x32x16_bf16 v[32:47], v[160:163], v[136:139], v[32:47]
    ds_read_b128 v[128:131], v22 offset:0
    ds_read_b64_tr_b16 v[152:153], v25 offset:20480
    s_waitcnt lgkmcnt(10)
    v_mfma_f32_32x32x16_bf16 v[48:63], v[160:163], v[140:143], v[48:63]
    ds_read_b64_tr_b16 v[154:155], v25 offset:20992
    s_waitcnt lgkmcnt(9)
    v_mfma_f32_32x32x16_bf16 v[64:79], v[136:139], v[164:167], v[64:79]
    ds_read_b128 v[132:135], v22 offset:4096
    ds_read_b64_tr_b16 v[156:157], v25 offset:22528
    v_mfma_f32_32x32x16_bf16 v[80:95], v[140:143], v[164:167], v[80:95]
    ds_read_b64_tr_b16 v[158:159], v25 offset:23040
    ds_add_u32 v245, v247 offset:0
    s_waitcnt lgkmcnt(10)
    v_mfma_f32_32x32x16_bf16 v[32:47], v[168:171], v[144:147], v[32:47]
    ds_read_b128 v[136:139], v23 offset:0
    ds_read_b64_tr_b16 v[160:161], v25 offset:24576
    s_waitcnt lgkmcnt(11)
    v_mfma_f32_32x32x16_bf16 v[48:63], v[168:171], v[148:151], v[48:63]
    ds_read_b64_tr_b16 v[162:163], v25 offset:25088
    s_waitcnt lgkmcnt(10)
    v_mfma_f32_32x32x16_bf16 v[64:79], v[144:147], v[172:175], v[64:79]
    ds_read_b128 v[140:143], v23 offset:4096
    ds_read_b64_tr_b16 v[164:165], v25 offset:26624
    v_mfma_f32_32x32x16_bf16 v[80:95], v[148:151], v[172:175], v[80:95]
    ds_read_b64_tr_b16 v[166:167], v25 offset:27136
    s_waitcnt lgkmcnt(10)
    v_mfma_f32_32x32x16_bf16 v[32:47], v[152:155], v[128:131], v[32:47]
    ds_read_b128 v[144:147], v24 offset:0
    ds_read_b64_tr_b16 v[168:169], v25 offset:28672
    s_waitcnt lgkmcnt(11)
    v_mfma_f32_32x32x16_bf16 v[48:63], v[152:155], v[132:135], v[48:63]
    ds_read_b64_tr_b16 v[170:171], v25 offset:29184
    ds_read_b32 v246, v244
    s_waitcnt lgkmcnt(11)
    v_mfma_f32_32x32x16_bf16 v[64:79], v[128:131], v[156:159], v[64:79]
    ds_read_b128 v[148:151], v24 offset:4096
    ds_read_b64_tr_b16 v[172:173], v25 offset:30720
    v_mfma_f32_32x32x16_bf16 v[80:95], v[132:135], v[156:159], v[80:95]
    ds_read_b64_tr_b16 v[174:175], v25 offset:31232
    s_waitcnt lgkmcnt(10)
    v_mfma_f32_32x32x16_bf16 v[32:47], v[160:163], v[136:139], v[32:47]
    s_waitcnt lgkmcnt(3)
    s_mov_b32 s35, 4286578688
L_cl_87:
    v_cmp_gt_u32 vcc, 4, v246
    s_cbranch_vccz L_cok_88
    ds_read_b32 v246, v244 offset:0
    s_add_u32 s35, s35, 1
    s_waitcnt lgkmcnt(0)
    s_cbranch_scc0 L_cl_87
L_cok_88:
    ds_read_b128 v[128:131], v21 offset:32768
    ds_read_b64_tr_b16 v[152:153], v25 offset:49152
    v_mfma_f32_32x32x16_bf16 v[48:63], v[160:163], v[140:143], v[48:63]
    ds_read_b64_tr_b16 v[154:155], v25 offset:49664
    v_mfma_f32_32x32x16_bf16 v[64:79], v[136:139], v[164:167], v[64:79]
    ds_read_b128 v[132:135], v21 offset:36864
    ds_read_b64_tr_b16 v[156:157], v25 offset:51200
    v_mfma_f32_32x32x16_bf16 v[80:95], v[140:143], v[164:167], v[80:95]
    ds_read_b64_tr_b16 v[158:159], v25 offset:51712
    v_mfma_f32_32x32x16_bf16 v[32:47], v[168:171], v[144:147], v[32:47]
    ds_read_b128 v[136:139], v22 offset:32768
    ds_read_b64_tr_b16 v[160:161], v25 offset:53248
    s_waitcnt lgkmcnt(10)
    v_mfma_f32_32x32x16_bf16 v[48:63], v[168:171], v[148:151], v[48:63]
    ds_read_b64_tr_b16 v[162:163], v25 offset:53760
    s_waitcnt lgkmcnt(9)
    v_mfma_f32_32x32x16_bf16 v[64:79], v[144:147], v[172:175], v[64:79]
    ds_read_b128 v[140:143], v22 offset:36864
    ds_read_b64_tr_b16 v[164:165], v25 offset:55296
    v_mfma_f32_32x32x16_bf16 v[80:95], v[148:151], v[172:175], v[80:95]
    ds_read_b64_tr_b16 v[166:167], v25 offset:55808
    ds_add_u32 v245, v247 offset:0
    s_waitcnt lgkmcnt(10)
    v_mfma_f32_32x32x16_bf16 v[32:47], v[152:155], v[128:131], v[32:47]
    ds_read_b128 v[144:147], v23 offset:32768
    ds_read_b64_tr_b16 v[168:169], v25 offset:57344
    s_waitcnt lgkmcnt(11)
    v_mfma_f32_32x32x16_bf16 v[48:63], v[152:155], v[132:135], v[48:63]
    ds_read_b64_tr_b16 v[170:171], v25 offset:57856
    s_waitcnt lgkmcnt(10)
    v_mfma_f32_32x32x16_bf16 v[64:79], v[128:131], v[156:159], v[64:79]
    ds_read_b128 v[148:151], v23 offset:36864
    ds_read_b64_tr_b16 v[172:173], v25 offset:59392
    v_mfma_f32_32x32x16_bf16 v[80:95], v[132:135], v[156:159], v[80:95]
    ds_read_b64_tr_b16 v[174:175], v25 offset:59904
    s_waitcnt lgkmcnt(10)
    v_mfma_f32_32x32x16_bf16 v[32:47], v[160:163], v[136:139], v[32:47]
    ds_read_b128 v[128:131], v24 offset:32768
    ds_read_b64_tr_b16 v[152:153], v25 offset:61440
    s_waitcnt lgkmcnt(11)
    v_mfma_f32_32x32x16_bf16 v[48:63], v[160:163], v[140:143], v[48:63]
    ds_read_b64_tr_b16 v[154:155], v25 offset:61952
    ds_read_b32 v246, v244
    s_waitcnt lgkmcnt(11)
    v_mfma_f32_32x32x16_bf16 v[64:79], v[136:139], v[164:167], v[64:79]
    ds_read_b128 v[132:135], v24 offset:36864
    ds_read_b64_tr_b16 v[156:157], v25 offset:63488
    v_mfma_f32_32x32x16_bf16 v[80:95], v[140:143], v[164:167], v[80:95]
    ds_read_b64_tr_b16 v[158:159], v25 offset:64000
    s_waitcnt lgkmcnt(10)
    v_mfma_f32_32x32x16_bf16 v[32:47], v[168:171], v[144:147], v[32:47]
    s_waitcnt lgkmcnt(3)
    s_mov_b32 s35, 4286578688
L_cl_89:
    v_cmp_gt_u32 vcc, 5, v246
    s_cbranch_vccz L_cok_90
    ds_read_b32 v246, v244 offset:0
    s_add_u32 s35, s35, 1
    s_waitcnt lgkmcnt(0)
    s_cbranch_scc0 L_cl_89
L_cok_90:
    ds_read_b128 v[136:139], v26 offset:0
    ds_read_b64_tr_b16 v[160:161], v30 offset:16384
    v_mfma_f32_32x32x16_bf16 v[48:63], v[168:171], v[148:151], v[48:63]
    ds_read_b64_tr_b16 v[162:163], v30 offset:16896
    v_mfma_f32_32x32x16_bf16 v[64:79], v[144:147], v[172:175], v[64:79]
    ds_read_b128 v[140:143], v26 offset:4096
    ds_read_b64_tr_b16 v[164:165], v30 offset:18432
    v_mfma_f32_32x32x16_bf16 v[80:95], v[148:151], v[172:175], v[80:95]
    ds_read_b64_tr_b16 v[166:167], v30 offset:18944
    v_mfma_f32_32x32x16_bf16 v[32:47], v[152:155], v[128:131], v[32:47]
    ds_read_b128 v[144:147], v27 offset:0
    ds_read_b64_tr_b16 v[168:169], v30 offset:20480
    s_waitcnt lgkmcnt(10)
    v_mfma_f32_32x32x16_bf16 v[48:63], v[152:155], v[132:135], v[48:63]
    ds_read_b64_tr_b16 v[170:171], v30 offset:20992
    s_waitcnt lgkmcnt(9)
    v_mfma_f32_32x32x16_bf16 v[64:79], v[128:131], v[156:159], v[64:79]
    ds_read_b128 v[148:151], v27 offset:4096
    ds_read_b64_tr_b16 v[172:173], v30 offset:22528
    v_mfma_f32_32x32x16_bf16 v[80:95], v[132:135], v[156:159], v[80:95]
    ds_read_b64_tr_b16 v[174:175], v30 offset:23040
    ds_add_u32 v245, v247 offset:0
    s_waitcnt lgkmcnt(10)
    v_mfma_f32_32x32x16_bf16 v[32:47], v[160:163], v[136:139], v[32:47]
    ds_read_b128 v[128:131], v28 offset:0
    ds_read_b64_tr_b16 v[152:153], v30 offset:24576
    s_waitcnt lgkmcnt(11)
    v_mfma_f32_32x32x16_bf16 v[48:63], v[160:163], v[140:143], v[48:63]
    ds_read_b64_tr_b16 v[154:155], v30 offset:25088
    s_waitcnt lgkmcnt(10)
    v_mfma_f32_32x32x16_bf16 v[64:79], v[136:139], v[164:167], v[64:79]
    ds_read_b128 v[132:135], v28 offset:4096
    ds_read_b64_tr_b16 v[156:157], v30 offset:26624
    v_mfma_f32_32x32x16_bf16 v[80:95], v[140:143], v[164:167], v[80:95]
    ds_read_b64_tr_b16 v[158:159], v30 offset:27136
    s_waitcnt lgkmcnt(10)
    v_mfma_f32_32x32x16_bf16 v[32:47], v[168:171], v[144:147], v[32:47]
    ds_read_b128 v[136:139], v29 offset:0
    ds_read_b64_tr_b16 v[160:161], v30 offset:28672
    s_waitcnt lgkmcnt(11)
    v_mfma_f32_32x32x16_bf16 v[48:63], v[168:171], v[148:151], v[48:63]
    ds_read_b64_tr_b16 v[162:163], v30 offset:29184
    ds_read_b32 v246, v244
    s_waitcnt lgkmcnt(11)
    v_mfma_f32_32x32x16_bf16 v[64:79], v[144:147], v[172:175], v[64:79]
    ds_read_b128 v[140:143], v29 offset:4096
    ds_read_b64_tr_b16 v[164:165], v30 offset:30720
    v_mfma_f32_32x32x16_bf16 v[80:95], v[148:151], v[172:175], v[80:95]
    ds_read_b64_tr_b16 v[166:167], v30 offset:31232
    s_waitcnt lgkmcnt(10)
    v_mfma_f32_32x32x16_bf16 v[32:47], v[152:155], v[128:131], v[32:47]
    s_waitcnt lgkmcnt(3)
    s_mov_b32 s35, 4286578688
L_cl_91:
    v_cmp_gt_u32 vcc, 6, v246
    s_cbranch_vccz L_cok_92
    ds_read_b32 v246, v244 offset:0
    s_add_u32 s35, s35, 1
    s_waitcnt lgkmcnt(0)
    s_cbranch_scc0 L_cl_91
L_cok_92:
    ds_read_b128 v[144:147], v16 offset:0
    ds_read_b64_tr_b16 v[168:169], v20 offset:16384
    v_mfma_f32_32x32x16_bf16 v[48:63], v[152:155], v[132:135], v[48:63]
    ds_read_b64_tr_b16 v[170:171], v20 offset:16896
    v_mfma_f32_32x32x16_bf16 v[64:79], v[128:131], v[156:159], v[64:79]
    ds_read_b128 v[148:151], v16 offset:4096
    ds_read_b64_tr_b16 v[172:173], v20 offset:18432
    v_mfma_f32_32x32x16_bf16 v[80:95], v[132:135], v[156:159], v[80:95]
    ds_read_b64_tr_b16 v[174:175], v20 offset:18944
    buffer_load_dwordx2 v[240:241], v15, s[24:27], 0 offen sc1
    v_mfma_f32_32x32x16_bf16 v[32:47], v[160:163], v[136:139], v[32:47]
    ds_read_b128 v[128:131], v17 offset:0
    ds_read_b64_tr_b16 v[152:153], v20 offset:20480
    s_waitcnt lgkmcnt(10)
    v_mfma_f32_32x32x16_bf16 v[48:63], v[160:163], v[140:143], v[48:63]
    ds_read_b64_tr_b16 v[154:155], v20 offset:20992
    s_waitcnt lgkmcnt(9)
    v_mfma_f32_32x32x16_bf16 v[64:79], v[136:139], v[164:167], v[64:79]
    ds_read_b128 v[132:135], v17 offset:4096
    ds_read_b64_tr_b16 v[156:157], v20 offset:22528
    v_mfma_f32_32x32x16_bf16 v[80:95], v[140:143], v[164:167], v[80:95]
    ds_read_b64_tr_b16 v[158:159], v20 offset:23040
    ds_add_u32 v245, v247 offset:0
    s_waitcnt lgkmcnt(10)
    v_mfma_f32_32x32x16_bf16 v[32:47], v[168:171], v[144:147], v[32:47]
    ds_read_b128 v[136:139], v18 offset:0
    ds_read_b64_tr_b16 v[160:161], v20 offset:24576
    s_waitcnt lgkmcnt(11)
    v_mfma_f32_32x32x16_bf16 v[48:63], v[168:171], v[148:151], v[48:63]
    ds_read_b64_tr_b16 v[162:163], v20 offset:25088
    s_waitcnt lgkmcnt(10)
    v_mfma_f32_32x32x16_bf16 v[64:79], v[144:147], v[172:175], v[64:79]
    ds_read_b128 v[140:143], v18 offset:4096
    ds_read_b64_tr_b16 v[164:165], v20 offset:26624
    v_mfma_f32_32x32x16_bf16 v[80:95], v[148:151], v[172:175], v[80:95]
    ds_read_b64_tr_b16 v[166:167], v20 offset:27136
    s_waitcnt lgkmcnt(10)
    v_mfma_f32_32x32x16_bf16 v[32:47], v[152:155], v[128:131], v[32:47]
    ds_read_b128 v[144:147], v19 offset:0
    ds_read_b64_tr_b16 v[168:169], v20 offset:28672
    s_waitcnt lgkmcnt(11)
    v_mfma_f32_32x32x16_bf16 v[48:63], v[152:155], v[132:135], v[48:63]
    ds_read_b64_tr_b16 v[170:171], v20 offset:29184
    ds_read_b32 v246, v244
    s_waitcnt lgkmcnt(11)
    v_mfma_f32_32x32x16_bf16 v[64:79], v[128:131], v[156:159], v[64:79]
    ds_read_b128 v[148:151], v19 offset:4096
    ds_read_b64_tr_b16 v[172:173], v20 offset:30720
    v_mfma_f32_32x32x16_bf16 v[80:95], v[132:135], v[156:159], v[80:95]
    ds_read_b64_tr_b16 v[174:175], v20 offset:31232
    s_waitcnt lgkmcnt(10)
    v_mfma_f32_32x32x16_bf16 v[32:47], v[160:163], v[136:139], v[32:47]
    s_waitcnt lgkmcnt(3)
    s_mov_b32 s35, 4286578688
L_cl_93:
    v_cmp_gt_u32 vcc, 7, v246
    s_cbranch_vccz L_cok_94
    ds_read_b32 v246, v244 offset:0
    s_add_u32 s35, s35, 1
    s_waitcnt lgkmcnt(0)
    s_cbranch_scc0 L_cl_93
L_cok_94:
    ds_read_b128 v[128:131], v16 offset:32768
    ds_read_b64_tr_b16 v[152:153], v20 offset:49152
    v_mfma_f32_32x32x16_bf16 v[48:63], v[160:163], v[140:143], v[48:63]
    ds_read_b64_tr_b16 v[154:155], v20 offset:49664
    v_mfma_f32_32x32x16_bf16 v[64:79], v[136:139], v[164:167], v[64:79]
    ds_read_b128 v[132:135], v16 offset:36864
    ds_read_b64_tr_b16 v[200:201], v20 offset:51200
    v_mfma_f32_32x32x16_bf16 v[80:95], v[140:143], v[164:167], v[80:95]
    ds_read_b64_tr_b16 v[202:203], v20 offset:51712
    v_mfma_f32_32x32x16_bf16 v[32:47], v[168:171], v[144:147], v[32:47]
    ds_read_b128 v[136:139], v17 offset:32768
    ds_read_b64_tr_b16 v[160:161], v20 offset:53248
    s_waitcnt lgkmcnt(10)
    v_mfma_f32_32x32x16_bf16 v[48:63], v[168:171], v[148:151], v[48:63]
    ds_read_b64_tr_b16 v[162:163], v20 offset:53760
    s_waitcnt lgkmcnt(9)
    v_mfma_f32_32x32x16_bf16 v[64:79], v[144:147], v[172:175], v[64:79]
    ds_read_b128 v[140:143], v17 offset:36864
    ds_read_b64_tr_b16 v[204:205], v20 offset:55296
    v_mfma_f32_32x32x16_bf16 v[80:95], v[148:151], v[172:175], v[80:95]
    ds_read_b64_tr_b16 v[206:207], v20 offset:55808
    ds_add_u32 v245, v247 offset:0
    s_waitcnt lgkmcnt(10)
    v_mfma_f32_32x32x16_bf16 v[32:47], v[152:155], v[128:131], v[32:47]
    ds_read_b128 v[144:147], v18 offset:32768
    ds_read_b64_tr_b16 v[168:169], v20 offset:57344
    ds_read_b64_tr_b16 v[170:171], v20 offset:57856
    s_waitcnt lgkmcnt(12)
    v_mfma_f32_32x32x16_bf16 v[48:63], v[152:155], v[132:135], v[48:63]
    ds_read_b128 v[148:151], v18 offset:36864
    ds_read_b64_tr_b16 v[208:209], v20 offset:59392
    ds_read_b64_tr_b16 v[210:211], v20 offset:59904
    s_waitcnt lgkmcnt(10)
    v_mfma_f32_32x32x16_bf16 v[32:47], v[160:163], v[136:139], v[32:47]
    ds_read_b128 v[192:195], v19 offset:32768
    ds_read_b64_tr_b16 v[152:153], v20 offset:61440
    ds_read_b64_tr_b16 v[154:155], v20 offset:61952
    s_waitcnt lgkmcnt(12)
    v_mfma_f32_32x32x16_bf16 v[48:63], v[160:163], v[140:143], v[48:63]
    ds_read_b128 v[196:199], v19 offset:36864
    ds_read_b64_tr_b16 v[212:213], v20 offset:63488
    ds_read_b64_tr_b16 v[214:215], v20 offset:64000
    s_waitcnt lgkmcnt(9)
    v_mfma_f32_32x32x16_bf16 v[32:47], v[168:171], v[144:147], v[32:47]
    s_waitcnt lgkmcnt(8)
    v_mfma_f32_32x32x16_bf16 v[48:63], v[168:171], v[148:151], v[48:63]
    ds_read_b32 v246, v244 offset:512
    s_waitcnt lgkmcnt(4)
    v_mfma_f32_32x32x16_bf16 v[32:47], v[152:155], v[192:195], v[32:47]
    s_waitcnt lgkmcnt(3)
    v_mfma_f32_32x32x16_bf16 v[48:63], v[152:155], v[196:199], v[48:63]
    s_waitcnt lgkmcnt(0)
    ds_add_u32 v245, v247 offset:0
    v_mfma_f32_32x32x16_bf16 v[64:79], v[128:131], v[200:203], v[64:79]
    v_mov_b32 v10, 0x3f803f80
    s_mov_b32 s64, 0x10000000
    s_mov_b32 s65, 0x10000000
    s_add_u32 s63, s67, s37
    s_add_u32 s62, s63, 4096
    v_mfma_f32_32x32x16_bf16 v[64:79], v[136:139], v[204:207], v[64:79]
    s_nop 1
    v_cvt_pk_bf16_f32 v32, v32, v33
    v_cvt_pk_bf16_f32 v33, v34, v35
    v_cvt_pk_bf16_f32 v34, v36, v37
    v_cvt_pk_bf16_f32 v35, v38, v39
    v_mfma_f32_32x32x16_bf16 v[64:79], v[144:147], v[208:211], v[64:79]
    v_cvt_pk_bf16_f32 v36, v40, v41
    v_cvt_pk_bf16_f32 v37, v42, v43
    v_cvt_pk_bf16_f32 v38, v44, v45
    v_cvt_pk_bf16_f32 v39, v46, v47
    v_mfma_f32_32x32x16_bf16 v[64:79], v[192:195], v[212:215], v[64:79]
    v_cndmask_b32 v38, v38, v10, s[68:69]
    buffer_store_dwordx4 v[32:35], v9, s[16:19], s63 offen offset:0 sc1
    buffer_store_dwordx4 v[36:39], v9, s[16:19], s63 offen offset:1024 sc1
    v_cvt_pk_bf16_f32 v48, v48, v49
    v_mfma_f32_32x32x16_bf16 v[80:95], v[132:135], v[200:203], v[80:95]
    v_cvt_pk_bf16_f32 v49, v50, v51
    v_cvt_pk_bf16_f32 v50, v52, v53
    v_cvt_pk_bf16_f32 v51, v54, v55
    v_cvt_pk_bf16_f32 v52, v56, v57
    v_mfma_f32_32x32x16_bf16 v[80:95], v[140:143], v[204:207], v[80:95]
    v_cvt_pk_bf16_f32 v53, v58, v59
    v_cvt_pk_bf16_f32 v54, v60, v61
    v_cvt_pk_bf16_f32 v55, v62, v63
    v_cndmask_b32 v54, v54, v10, s[68:69]
    v_mfma_f32_32x32x16_bf16 v[80:95], v[148:151], v[208:211], v[80:95]
    buffer_store_dwordx4 v[48:51], v9, s[16:19], s62 offen offset:0 sc1
    buffer_store_dwordx4 v[52:55], v9, s[16:19], s62 offen offset:1024 sc1
    v_mfma_f32_32x32x16_bf16 v[80:95], v[196:199], v[212:215], v[80:95]
    s_mov_b32 s35, 4286578688
L_cl_95:
    v_cmp_gt_u32 vcc, 5, v246
    s_cbranch_vccz L_cok_96
    ds_read_b32 v246, v244 offset:512
    s_add_u32 s35, s35, 1
    s_waitcnt lgkmcnt(0)
    s_cbranch_scc0 L_cl_95
L_cok_96:
    v_cvt_pk_bf16_f32 v64, v64, v65
    v_cvt_pk_bf16_f32 v65, v66, v67
    v_cvt_pk_bf16_f32 v66, v68, v69
    v_cvt_pk_bf16_f32 v67, v70, v71
    v_cndmask_b32 v64, v64, v10, s[64:65]
    v_cndmask_b32 v65, v65, v10, s[64:65]
    v_cndmask_b32 v66, v66, v10, s[64:65]
    v_cndmask_b32 v67, v67, v10, s[64:65]
    buffer_store_dwordx4 v[64:67], v9, s[16:19], s63 offen offset:2048 sc1
    v_cvt_pk_bf16_f32 v68, v72, v73
    v_cvt_pk_bf16_f32 v69, v74, v75
    v_cvt_pk_bf16_f32 v70, v76, v77
    v_cvt_pk_bf16_f32 v71, v78, v79
    v_cndmask_b32 v68, v68, v10, s[64:65]
    v_cndmask_b32 v69, v69, v10, s[64:65]
    v_cndmask_b32 v70, v70, v10, s[64:65]
    v_cndmask_b32 v71, v71, v10, s[64:65]
    buffer_store_dwordx4 v[68:71], v9, s[16:19], s63 offen offset:3072 sc1
    v_cvt_pk_bf16_f32 v80, v80, v81
    v_cvt_pk_bf16_f32 v81, v82, v83
    v_cvt_pk_bf16_f32 v82, v84, v85
    v_cvt_pk_bf16_f32 v83, v86, v87
    v_cndmask_b32 v80, v80, v10, s[64:65]
    v_cndmask_b32 v81, v81, v10, s[64:65]
    v_cndmask_b32 v82, v82, v10, s[64:65]
    v_cndmask_b32 v83, v83, v10, s[64:65]
    buffer_store_dwordx4 v[80:83], v9, s[16:19], s62 offen offset:2048 sc1
    v_cvt_pk_bf16_f32 v84, v88, v89
    v_cvt_pk_bf16_f32 v85, v90, v91
    v_cvt_pk_bf16_f32 v86, v92, v93
    v_cvt_pk_bf16_f32 v87, v94, v95
    v_cndmask_b32 v84, v84, v10, s[64:65]
    v_cndmask_b32 v85, v85, v10, s[64:65]
    v_cndmask_b32 v86, v86, v10, s[64:65]
    v_cndmask_b32 v87, v87, v10, s[64:65]
    buffer_store_dwordx4 v[84:87], v9, s[16:19], s62 offen offset:3072 sc1
    ds_add_u32 v250, v247 offset:116
    ds_write_b128 v2, v[32:35] offset:0
    ds_write_b128 v2, v[36:39] offset:1024
    ds_write_b128 v2, v[64:67] offset:2048
    ds_write_b128 v2, v[68:71] offset:3072
    ds_write_b128 v2, v[48:51] offset:4096
    ds_write_b128 v2, v[52:55] offset:5120
    ds_write_b128 v2, v[80:83] offset:6144
    ds_write_b128 v2, v[84:87] offset:7168
    s_lshl_b32 s62, s51, 14
    s_lshl_b32 s63, s50, 12
    s_add_u32 s62, s62, s63
    s_add_u32 s62, s62, 131072
    v_add_u32 v176, s62, v9
    s_mov_b32 s63, 0xfffeb000
    s_cmp_eq_u32 s50, 0
    s_cselect_b32 s62, s63, 0xfffff000
    v_add_u32 v177, s62, v176
    s_mov_b32 s63, 0xfffeb000
    s_cmp_eq_u32 s50, 1
    s_cselect_b32 s62, s63, 0xfffff000
    v_add_u32 v178, s62, v177
    s_mov_b32 s63, 0xfffeb000
    s_cmp_eq_u32 s50, 2
    s_cselect_b32 s62, s63, 0xfffff000
    v_add_u32 v179, s62, v178
    s_mov_b32 s63, 0xfffeb000
    s_cmp_eq_u32 s50, 3
    s_cselect_b32 s62, s63, 0xfffff000
    v_add_u32 v180, s62, v179
    s_mov_b32 s63, 0xffffb000
    s_cmp_eq_u32 s50, 0
    s_cselect_b32 s62, s63, 0xfffff000
    v_add_u32 v181, s62, v180
    s_mov_b32 s63, 0xffffb000
    s_cmp_eq_u32 s50, 1
    s_cselect_b32 s62, s63, 0xfffff000
    v_add_u32 v182, s62, v181
    s_mov_b32 s63, 0xffffb000
    s_cmp_eq_u32 s50, 2
    s_cselect_b32 s62, s63, 0xfffff000
    v_add_u32 v183, s62, v182
    s_mov_b32 s63, 0xffffb000
    s_cmp_eq_u32 s50, 3
    s_cselect_b32 s62, s63, 0xfffff000
    v_add_u32 v184, s62, v183
    v_lshrrev_b32 v10, 4, v1
    v_lshlrev_b32 v11, 2, v10
    v_and_b32 v12, 15, v1
    v_xor_b32 v11, v11, v12
    v_mul_u32_u24 v248, 896, v10
    v_lshl_add_u32 v248, v11, 4, v248
    s_cmp_eq_u32 s32, 3
    s_cselect_b32 s62, 8, 64
    v_mov_b32 v12, 0x7ff00000
    v_cmp_le_u32 vcc, s62, v11
    s_lshl_b32 s63, s51, 7
    v_add_u32 v251, s63, v249
    v_cndmask_b32 v248, v248, v12, vcc
    s_waitcnt lgkmcnt(0)
    ds_add_u32 v250, v247 offset:636
    s_lshr_b32 s63, s59, 8
    s_lshl_b32 s64, s31, 3
    s_add_u32 s63, s63, s64
    s_add_u32 s63, s63, 0x1000000
    s_waitcnt vmcnt(0)
    s_mov_b32 s35, 0
L_nlp_97:
    v_readfirstlane_b32 s60, v240
    v_readfirstlane_b32 s61, v241
    s_add_u32 s35, s35, 1
    s_cmp_lg_u32 s60, 0
    s_cbranch_scc1 L_nok_98
    s_cmp_gt_u32 s35, 1048576
    s_cbranch_scc1 L_nok_98
    buffer_load_dwordx2 v[240:241], v15, s[24:27], 0 offen sc1
    s_waitcnt vmcnt(0)
    s_branch L_nlp_97
L_nok_98:
    s_mov_b64 exec, 1
    buffer_store_dwordx2 v[240:241], v15, s[16:19], s63 offen sc1
    s_mov_b64 exec, -1
    v_mov_b32 v10, 0xf149f2ca
    s_mov_b32 s64, 0xffffffff
    s_mov_b32 s65, 0xfffffff0
    v_cndmask_b32 v96, v10, 0, s[64:65]
    v_cndmask_b32 v112, 0, v10, s[64:65]
    s_mov_b32 s64, 0xfffffffe
    s_mov_b32 s65, 0xffffffe0
    v_cndmask_b32 v97, v10, 0, s[64:65]
    v_cndmask_b32 v113, 0, v10, s[64:65]
    s_mov_b32 s64, 0xfffffffc
    s_mov_b32 s65, 0xffffffc0
    v_cndmask_b32 v98, v10, 0, s[64:65]
    v_cndmask_b32 v114, 0, v10, s[64:65]
    s_mov_b32 s64, 0xfffffff8
    s_mov_b32 s65, 0xffffff80
    v_cndmask_b32 v99, v10, 0, s[64:65]
    v_cndmask_b32 v115, 0, v10, s[64:65]
    s_mov_b32 s64, 0xffffff00
    s_mov_b32 s65, 0xfffff000
    v_cndmask_b32 v100, v10, 0, s[64:65]
    v_cndmask_b32 v116, 0, v10, s[64:65]
    s_mov_b32 s64, 0xfffffe00
    s_mov_b32 s65, 0xffffe000
    v_cndmask_b32 v101, v10, 0, s[64:65]
    v_cndmask_b32 v117, 0, v10, s[64:65]
    s_mov_b32 s64, 0xfffffc00
    s_mov_b32 s65, 0xffffc000
    v_cndmask_b32 v102, v10, 0, s[64:65]
    v_cndmask_b32 v118, 0, v10, s[64:65]
    s_mov_b32 s64, 0xfffff800
    s_mov_b32 s65, 0xffff8000
    v_cndmask_b32 v103, v10, 0, s[64:65]
    v_cndmask_b32 v119, 0, v10, s[64:65]
    s_mov_b32 s64, 0xffff0000
    s_mov_b32 s65, 0xfff00000
    v_cndmask_b32 v104, v10, 0, s[64:65]
    v_cndmask_b32 v120, 0, v10, s[64:65]
    s_mov_b32 s64, 0xfffe0000
    s_mov_b32 s65, 0xffe00000
    v_cndmask_b32 v105, v10, 0, s[64:65]
    v_cndmask_b32 v121, 0, v10, s[64:65]
    s_mov_b32 s64, 0xfffc0000
    s_mov_b32 s65, 0xffc00000
    v_cndmask_b32 v106, v10, 0, s[64:65]
    v_cndmask_b32 v122, 0, v10, s[64:65]
    s_mov_b32 s64, 0xfff80000
    s_mov_b32 s65, 0xff800000
    v_cndmask_b32 v107, v10, 0, s[64:65]
    v_cndmask_b32 v123, 0, v10, s[64:65]
    s_mov_b32 s64, 0xff000000
    s_mov_b32 s65, 0xf0000000
    v_cndmask_b32 v108, v10, 0, s[64:65]
    v_cndmask_b32 v124, 0, v10, s[64:65]
    s_mov_b32 s64, 0xfe000000
    s_mov_b32 s65, 0xe0000000
    v_cndmask_b32 v109, v10, 0, s[64:65]
    v_cndmask_b32 v125, 0, v10, s[64:65]
    s_mov_b32 s64, 0xfc000000
    s_mov_b32 s65, 0xc0000000
    v_cndmask_b32 v110, v10, 0, s[64:65]
    v_cndmask_b32 v126, 0, v10, s[64:65]
    s_mov_b32 s64, 0xf8000000
    s_mov_b32 s65, 0x80000000
    v_cndmask_b32 v111, v10, 0, s[64:65]
    v_cndmask_b32 v127, 0, v10, s[64:65]
    s_cmp_lt_u32 s31, 2
    s_cbranch_scc1 L_ldd_99
    s_lshr_b32 s65, s50, 1
    s_mov_b32 s35, 0
L_spin_100:
    ds_read_b32 v246, v244 offset:512
    s_add_u32 s35, s35, 1
    s_waitcnt lgkmcnt(0)
    v_cmp_gt_u32 vcc, 7, v246
    s_cmp_gt_u32 s35, 8388608
    s_cbranch_scc1 L_spok_101
    s_cbranch_vccnz L_spin_100
L_spok_101:
    s_mov_b32 s35, 0
L_spin_102:
    ds_read_b32 v246, v249 offset:956
    s_add_u32 s35, s35, 1
    s_waitcnt lgkmcnt(0)
    v_cmp_gt_u32 vcc, 4, v246
    s_cmp_gt_u32 s35, 8388608
    s_cbranch_scc1 L_spok_103
    s_cbranch_vccnz L_spin_102
L_spok_103:
    s_and_b32 s64, s50, 1
    s_add_u32 s67, s65, 1
    s_lshl_b32 s62, s67, 15
    s_sub_u32 s54, s59, s62
    s_lshr_b32 s62, s54, 8
    s_lshl_b32 s63, s64, 4
    s_add_u32 s62, s62, s63
    s_add_u32 s62, s62, 0x1000000
    v_and_b32 v10, 1, v1
    v_lshlrev_b32 v10, 3, v10
    v_add_u32 v10, s62, v10
    v_and_b32 v11, 2, v1
    v_lshl_add_u32 v10, v11, 5, v10
    s_lshl_b32 s62, s50, 7
    s_lshl_b32 s63, s65, 6
    s_sub_u32 s62, s62, s63
    s_add_u32 s62, s62, 124
    v_add_u32 v245, s62, v250
    s_mul_i32 s62, s67, 33280
    s_sub_u32 s62, s37, s62
    s_lshl_b32 s64, s64, 14
    s_add_u32 s56, s62, s64
    s_lshl_b32 s62, s65, 15
    s_sub_u32 s62, 32768, s62
    s_add_u32 s64, s64, s62
    s_cmp_lt_u32 s30, s67
    s_cselect_b32 s56, 0x7ff00000, s56
    s_cmp_lt_u32 s30, s67
    s_cbranch_scc1 L_nopoll_104
    s_mov_b64 exec, 3
    s_mov_b32 s35, 0
L_poll_105:
    buffer_load_dwordx2 v[242:243], v10, s[16:19], 0 offen sc1
    s_add_u32 s35, s35, 1
    s_waitcnt vmcnt(0)
    v_cmp_ne_u64 vcc, s[60:61], v[242:243]
    s_cmp_gt_u32 s35, 1048576
    s_cbranch_scc1 L_pok_106
    s_cbranch_vccnz L_poll_105
L_pok_106:
    s_mov_b64 exec, -1
L_nopoll_104:
    s_add_u32 m0, s64, 12288
    s_add_u32 s62, s56, 12288
    buffer_load_dwordx4 v9, s[16:19], s62 offen offset:0 sc1 lds
    buffer_load_dwordx4 v9, s[16:19], s62 offen offset:1024 sc1 lds
    buffer_load_dwordx4 v9, s[16:19], s62 offen offset:2048 sc1 lds
    buffer_load_dwordx4 v9, s[16:19], s62 offen offset:3072 sc1 lds
    s_add_u32 m0, s64, 8192
    s_add_u32 s62, s56, 8192
    buffer_load_dwordx4 v9, s[16:19], s62 offen offset:0 sc1 lds
    buffer_load_dwordx4 v9, s[16:19], s62 offen offset:1024 sc1 lds
    buffer_load_dwordx4 v9, s[16:19], s62 offen offset:2048 sc1 lds
    buffer_load_dwordx4 v9, s[16:19], s62 offen offset:3072 sc1 lds
    s_add_u32 m0, s64, 4096
    s_add_u32 s62, s56, 4096
    buffer_load_dwordx4 v9, s[16:19], s62 offen offset:0 sc1 lds
    buffer_load_dwordx4 v9, s[16:19], s62 offen offset:1024 sc1 lds
    buffer_load_dwordx4 v9, s[16:19], s62 offen offset:2048 sc1 lds
    buffer_load_dwordx4 v9, s[16:19], s62 offen offset:3072 sc1 lds
    s_add_u32 m0, s64, 0
    s_add_u32 s62, s56, 0
    buffer_load_dwordx4 v9, s[16:19], s62 offen offset:0 sc1 lds
    buffer_load_dwordx4 v9, s[16:19], s62 offen offset:1024 sc1 lds
    buffer_load_dwordx4 v9, s[16:19], s62 offen offset:2048 sc1 lds
    buffer_load_dwordx4 v9, s[16:19], s62 offen offset:3072 sc1 lds
L_ldd_99:
    s_lshl_b32 s62, s50, 11
    s_add_u32 s62, s62, 122880
    v_add_u32 v10, s62, v9
    s_mov_b32 s35, 0
L_spin_107:
    ds_read_b32 v246, v249 offset:636
    s_add_u32 s35, s35, 1
    s_waitcnt lgkmcnt(0)
    v_cmp_gt_u32 vcc, 4, v246
    s_cmp_gt_u32 s35, 8388608
    s_cbranch_scc1 L_spok_108
    s_cbranch_vccnz L_spin_107
L_spok_108:
    s_mov_b32 s35, 0
L_spin_109:
    ds_read_b32 v246, v249 offset:764
    s_add_u32 s35, s35, 1
    s_waitcnt lgkmcnt(0)
    v_cmp_gt_u32 vcc, 4, v246
    s_cmp_gt_u32 s35, 8388608
    s_cbranch_scc1 L_spok_110
    s_cbranch_vccnz L_spin_109
L_spok_110:
    ds_read_b128 v[16:19], v10 offset:0
    ds_read_b128 v[20:23], v10 offset:1024
L_xA:
    ds_read2_b32 v[252:253], v251 offset0:31 offset1:79
    ds_read_b128 v[48:51], v176 offset:0
    ds_read_b128 v[52:55], v176 offset:1024
    s_waitcnt lgkmcnt(0)
    v_mfma_f32_32x32x16_bf16 v[128:143], v[48:51], v[16:19], v[96:111]
    v_mfma_f32_32x32x16_bf16 v[128:143], v[52:55], v[20:23], v[128:143]
    ds_add_u32 v250, v247 offset:828
    s_nop 10
    v_max3_f32 v80, v128, v129, v130
    v_max3_f32 v80, v80, v131, v132
    v_max3_f32 v80, v80, v133, v134
    v_max3_f32 v80, v80, v135, v136
    v_max3_f32 v80, v80, v137, v138
    v_max3_f32 v80, v80, v139, v140
    v_max3_f32 v80, v80, v141, v142
    v_max_f32 v80, v80, v143
    v_mov_b32 v81, v80
    s_nop 1
    v_permlane32_swap_b32 v80, v81
    s_nop 1
    v_max_f32 v80, v80, v81
    v_cvt_pk_bf16_f32 v81, -v80, 0
    v_lshlrev_b32 v82, 16, v81
    v_cndmask_b32 v22, v22, v81, s[68:69]
    v_add_f32 v128, v82, v128
    v_add_f32 v129, v82, v129
    v_add_f32 v130, v82, v130
    v_add_f32 v131, v82, v131
    v_add_f32 v132, v82, v132
    v_add_f32 v133, v82, v133
    v_add_f32 v134, v82, v134
    v_add_f32 v135, v82, v135
    v_add_f32 v136, v82, v136
    v_add_f32 v137, v82, v137
    v_add_f32 v138, v82, v138
    v_add_f32 v139, v82, v139
    v_add_f32 v140, v82, v140
    v_add_f32 v141, v82, v141
    v_add_f32 v142, v82, v142
    v_add_f32 v143, v82, v143
    s_cmp_lt_u32 s31, 2
    s_cbranch_scc1 L_ld_111
    s_cmp_ge_u32 s31, 4
    s_cbranch_scc1 L_ld_111
    s_waitcnt vmcnt(0)
    ds_add_u32 v245, v247 offset:0
L_ld_111:
    s_cmp_lg_u32 s50, 0
    s_cbranch_scc1 L_site_112
    s_mov_b32 s35, 4286578688
L_cl_113:
    v_cmp_gt_u32 vcc, 1, v252
    s_cbranch_vccz L_cok_114
    ds_read_b32 v252, v251 offset:124
    s_add_u32 s35, s35, 1
    s_waitcnt lgkmcnt(0)
    s_cbranch_scc0 L_cl_113
L_cok_114:
L_site_112:
    ds_read2_b32 v[252:253], v251 offset0:31 offset1:79
    ds_read_b128 v[56:59], v177 offset:0
    ds_read_b128 v[60:63], v177 offset:1024
    ds_read_b128 v[64:67], v176 offset:2048
    ds_read_b128 v[68:71], v176 offset:3072
    v_exp_f32 v128, v128
    v_exp_f32 v129, v129
    v_exp_f32 v130, v130
    v_exp_f32 v131, v131
    v_exp_f32 v132, v132
    v_exp_f32 v133, v133
    v_exp_f32 v134, v134
    v_exp_f32 v135, v135
    v_exp_f32 v136, v136
    v_exp_f32 v137, v137
    s_waitcnt lgkmcnt(2)
    v_mfma_f32_32x32x16_bf16 v[144:159], v[56:59], v[16:19], 0
    v_exp_f32 v138, v138
    v_exp_f32 v139, v139
    v_exp_f32 v140, v140
    v_exp_f32 v141, v141
    v_exp_f32 v142, v142
    v_exp_f32 v143, v143
    v_mfma_f32_32x32x16_bf16 v[144:159], v[60:63], v[20:23], v[144:159]
    v_cvt_pk_bf16_f32 v128, v128, v129
    v_cvt_pk_bf16_f32 v129, v130, v131
    v_cvt_pk_bf16_f32 v130, v132, v133
    v_cvt_pk_bf16_f32 v131, v134, v135
    v_cvt_pk_bf16_f32 v132, v136, v137
    v_cvt_pk_bf16_f32 v133, v138, v139
    v_cvt_pk_bf16_f32 v134, v140, v141
    v_cvt_pk_bf16_f32 v135, v142, v143
    s_cmp_lg_u32 s50, 1
    s_cbranch_scc1 L_site_115
    s_mov_b32 s35, 4286578688
L_cl_116:
    v_cmp_gt_u32 vcc, 1, v252
    s_cbranch_vccz L_cok_117
    ds_read_b32 v252, v251 offset:124
    s_add_u32 s35, s35, 1
    s_waitcnt lgkmcnt(0)
    s_cbranch_scc0 L_cl_116
L_cok_117:
L_site_115:
    ds_read2_b32 v[252:253], v251 offset0:31 offset1:79
    ds_read_b32 v254, v249 offset:828
    ds_read_b128 v[48:51], v178 offset:0
    ds_read_b128 v[52:55], v178 offset:1024
    ds_read_b128 v[72:75], v177 offset:2048
    ds_read_b128 v[76:79], v177 offset:3072
    s_waitcnt lgkmcnt(6)
    v_mfma_f32_32x32x16_bf16 v[32:47], v[64:67], v[128:131], 0
    v_exp_f32 v144, v144
    v_exp_f32 v145, v145
    v_exp_f32 v146, v146
    v_exp_f32 v147, v147
    v_exp_f32 v148, v148
    v_mfma_f32_32x32x16_bf16 v[32:47], v[68:71], v[132:135], v[32:47]
    v_exp_f32 v149, v149
    v_exp_f32 v150, v150
    v_exp_f32 v151, v151
    v_exp_f32 v152, v152
    v_exp_f32 v153, v153
    s_waitcnt lgkmcnt(2)
    v_mfma_f32_32x32x16_bf16 v[160:175], v[48:51], v[16:19], 0
    v_exp_f32 v154, v154
    v_exp_f32 v155, v155
    v_exp_f32 v156, v156
    v_exp_f32 v157, v157
    v_exp_f32 v158, v158
    v_exp_f32 v159, v159
    v_mfma_f32_32x32x16_bf16 v[160:175], v[52:55], v[20:23], v[160:175]
    v_cvt_pk_bf16_f32 v144, v144, v145
    v_cvt_pk_bf16_f32 v145, v146, v147
    v_cvt_pk_bf16_f32 v146, v148, v149
    v_cvt_pk_bf16_f32 v147, v150, v151
    v_cvt_pk_bf16_f32 v148, v152, v153
    v_cvt_pk_bf16_f32 v149, v154, v155
    v_cvt_pk_bf16_f32 v150, v156, v157
    v_cvt_pk_bf16_f32 v151, v158, v159
    s_cmp_ge_u32 s31, 2
    s_cbranch_scc1 L_r2f_118
    s_lshr_b32 s65, s50, 1
    s_mov_b32 s35, 0
L_spin_119:
    ds_read_b32 v246, v244 offset:512
    s_add_u32 s35, s35, 1
    s_waitcnt lgkmcnt(0)
    v_cmp_gt_u32 vcc, 7, v246
    s_cmp_gt_u32 s35, 8388608
    s_cbranch_scc1 L_spok_120
    s_cbranch_vccnz L_spin_119
L_spok_120:
    s_mov_b32 s35, 0
L_spin_121:
    ds_read_b32 v246, v249 offset:956
    s_add_u32 s35, s35, 1
    s_waitcnt lgkmcnt(0)
    v_cmp_gt_u32 vcc, 4, v246
    s_cmp_gt_u32 s35, 8388608
    s_cbranch_scc1 L_spok_122
    s_cbranch_vccnz L_spin_121
L_spok_122:
    s_and_b32 s64, s50, 1
    s_add_u32 s67, s65, 1
    s_lshl_b32 s62, s67, 15
    s_sub_u32 s54, s59, s62
    s_lshr_b32 s62, s54, 8
    s_lshl_b32 s63, s64, 4
    s_add_u32 s62, s62, s63
    s_add_u32 s62, s62, 0x1000000
    v_and_b32 v10, 1, v1
    v_lshlrev_b32 v10, 3, v10
    v_add_u32 v10, s62, v10
    v_and_b32 v11, 2, v1
    v_lshl_add_u32 v10, v11, 5, v10
    s_lshl_b32 s62, s50, 7
    s_lshl_b32 s63, s65, 6
    s_sub_u32 s62, s62, s63
    s_add_u32 s62, s62, 124
    v_add_u32 v245, s62, v250
    s_mul_i32 s62, s67, 33280
    s_sub_u32 s62, s37, s62
    s_lshl_b32 s64, s64, 14
    s_add_u32 s56, s62, s64
    s_lshl_b32 s62, s65, 15
    s_sub_u32 s62, 32768, s62
    s_add_u32 s64, s64, s62
    s_cmp_lt_u32 s30, s67
    s_cselect_b32 s56, 0x7ff00000, s56
    s_cmp_lt_u32 s30, s67
    s_cbranch_scc1 L_nopoll_123
    s_mov_b64 exec, 3
    s_mov_b32 s35, 0
L_poll_124:
    buffer_load_dwordx2 v[242:243], v10, s[16:19], 0 offen sc1
    s_add_u32 s35, s35, 1
    s_waitcnt vmcnt(0)
    v_cmp_ne_u64 vcc, s[60:61], v[242:243]
    s_cmp_gt_u32 s35, 1048576
    s_cbranch_scc1 L_pok_125
    s_cbranch_vccnz L_poll_124
L_pok_125:
    s_mov_b64 exec, -1
L_nopoll_123:
    s_add_u32 m0, s64, 12288
    s_add_u32 s62, s56, 12288
    buffer_load_dwordx4 v9, s[16:19], s62 offen offset:0 sc1 lds
    buffer_load_dwordx4 v9, s[16:19], s62 offen offset:1024 sc1 lds
    buffer_load_dwordx4 v9, s[16:19], s62 offen offset:2048 sc1 lds
    buffer_load_dwordx4 v9, s[16:19], s62 offen offset:3072 sc1 lds
    s_add_u32 m0, s64, 8192
    s_add_u32 s62, s56, 8192
    buffer_load_dwordx4 v9, s[16:19], s62 offen offset:0 sc1 lds
    buffer_load_dwordx4 v9, s[16:19], s62 offen offset:1024 sc1 lds
    buffer_load_dwordx4 v9, s[16:19], s62 offen offset:2048 sc1 lds
    buffer_load_dwordx4 v9, s[16:19], s62 offen offset:3072 sc1 lds
    s_add_u32 m0, s64, 4096
    s_add_u32 s62, s56, 4096
    buffer_load_dwordx4 v9, s[16:19], s62 offen offset:0 sc1 lds
    buffer_load_dwordx4 v9, s[16:19], s62 offen offset:1024 sc1 lds
    buffer_load_dwordx4 v9, s[16:19], s62 offen offset:2048 sc1 lds
    buffer_load_dwordx4 v9, s[16:19], s62 offen offset:3072 sc1 lds
    s_add_u32 m0, s64, 0
    s_add_u32 s62, s56, 0
    buffer_load_dwordx4 v9, s[16:19], s62 offen offset:0 sc1 lds
    buffer_load_dwordx4 v9, s[16:19], s62 offen offset:1024 sc1 lds
    buffer_load_dwordx4 v9, s[16:19], s62 offen offset:2048 sc1 lds
    buffer_load_dwordx4 v9, s[16:19], s62 offen offset:3072 sc1 lds
L_r2f_118:
    s_cmp_lg_u32 s50, 2
    s_cbranch_scc1 L_site_126
    s_mov_b32 s35, 4286578688
L_cl_127:
    v_cmp_gt_u32 vcc, 1, v252
    s_cbranch_vccz L_cok_128
    ds_read_b32 v252, v251 offset:124
    s_add_u32 s35, s35, 1
    s_waitcnt lgkmcnt(0)
    s_cbranch_scc0 L_cl_127
L_cok_128:
L_site_126:
    ds_read2_b32 v[252:253], v251 offset0:31 offset1:79
    ds_read_b128 v[56:59], v179 offset:0
    ds_read_b128 v[60:63], v179 offset:1024
    ds_read_b128 v[64:67], v178 offset:2048
    ds_read_b128 v[68:71], v178 offset:3072
    s_waitcnt lgkmcnt(5)
    v_mfma_f32_32x32x16_bf16 v[32:47], v[72:75], v[144:147], v[32:47]
    v_exp_f32 v160, v160
    v_exp_f32 v161, v161
    v_exp_f32 v162, v162
    v_exp_f32 v163, v163
    v_exp_f32 v164, v164
    v_mfma_f32_32x32x16_bf16 v[32:47], v[76:79], v[148:151], v[32:47]
    s_mov_b32 s35, 4286578688
L_cl_129:
    v_cmp_gt_u32 vcc, 8, v254
    s_cbranch_vccz L_cok_130
    ds_read_b32 v254, v249 offset:828
    s_add_u32 s35, s35, 1
    s_waitcnt lgkmcnt(0)
    s_cbranch_scc0 L_cl_129
L_cok_130:
    s_add_u32 m0, s52, 65536
    s_add_u32 s65, s34, 0
    buffer_load_dwordx4 v248, s[12:15], s65 offen lds
    s_add_u32 m0, s52, 73728
    s_add_u32 s65, s34, 28672
    buffer_load_dwordx4 v248, s[12:15], s65 offen lds
    v_exp_f32 v165, v165
    v_exp_f32 v166, v166
    v_exp_f32 v167, v167
    v_exp_f32 v168, v168
    v_exp_f32 v169, v169
    s_waitcnt lgkmcnt(2)
    v_mfma_f32_32x32x16_bf16 v[128:143], v[56:59], v[16:19], 0
    v_exp_f32 v170, v170
    v_exp_f32 v171, v171
    v_exp_f32 v172, v172
    v_exp_f32 v173, v173
    v_exp_f32 v174, v174
    v_exp_f32 v175, v175
    v_mfma_f32_32x32x16_bf16 v[128:143], v[60:63], v[20:23], v[128:143]
    v_cvt_pk_bf16_f32 v160, v160, v161
    v_cvt_pk_bf16_f32 v161, v162, v163
    v_cvt_pk_bf16_f32 v162, v164, v165
    v_cvt_pk_bf16_f32 v163, v166, v167
    v_cvt_pk_bf16_f32 v164, v168, v169
    v_cvt_pk_bf16_f32 v165, v170, v171
    v_cvt_pk_bf16_f32 v166, v172, v173
    v_cvt_pk_bf16_f32 v167, v174, v175
    s_cmp_lg_u32 s50, 3
    s_cbranch_scc1 L_site_133
    s_mov_b32 s35, 4286578688
L_cl_134:
    v_cmp_gt_u32 vcc, 1, v252
    s_cbranch_vccz L_cok_135
    ds_read_b32 v252, v251 offset:124
    s_add_u32 s35, s35, 1
    s_waitcnt lgkmcnt(0)
    s_cbranch_scc0 L_cl_134
L_cok_135:
L_site_133:
    ds_read2_b32 v[252:253], v251 offset0:31 offset1:79
    ds_read_b128 v[48:51], v180 offset:0
    ds_read_b128 v[52:55], v180 offset:1024
    ds_read_b128 v[72:75], v179 offset:2048
    ds_read_b128 v[76:79], v179 offset:3072
    s_waitcnt lgkmcnt(5)
    v_mfma_f32_32x32x16_bf16 v[32:47], v[64:67], v[160:163], v[32:47]
    v_exp_f32 v128, v128
    v_exp_f32 v129, v129
    v_exp_f32 v130, v130
    v_exp_f32 v131, v131
    v_exp_f32 v132, v132
    v_mfma_f32_32x32x16_bf16 v[32:47], v[68:71], v[164:167], v[32:47]
    s_add_u32 m0, s52, 81920
    s_add_u32 s65, s34, 57344
    buffer_load_dwordx4 v248, s[12:15], s65 offen lds
    s_cmp_eq_u32 s31, 7
    s_cbranch_scc1 L_wsk_137
    s_add_u32 m0, s52, 90112
    s_add_u32 s65, s34, 86016
    buffer_load_dwordx4 v248, s[12:15], s65 offen lds
L_wsk_137:
    v_exp_f32 v133, v133
    v_exp_f32 v134, v134
    v_exp_f32 v135, v135
    v_exp_f32 v136, v136
    v_exp_f32 v137, v137
    s_waitcnt lgkmcnt(2)
    v_mfma_f32_32x32x16_bf16 v[144:159], v[48:51], v[16:19], 0
    v_exp_f32 v138, v138
    v_exp_f32 v139, v139
    v_exp_f32 v140, v140
    v_exp_f32 v141, v141
    v_exp_f32 v142, v142
    v_exp_f32 v143, v143
    v_mfma_f32_32x32x16_bf16 v[144:159], v[52:55], v[20:23], v[144:159]
    v_cvt_pk_bf16_f32 v128, v128, v129
    v_cvt_pk_bf16_f32 v129, v130, v131
    v_cvt_pk_bf16_f32 v130, v132, v133
    v_cvt_pk_bf16_f32 v131, v134, v135
    v_cvt_pk_bf16_f32 v132, v136, v137
    v_cvt_pk_bf16_f32 v133, v138, v139
    v_cvt_pk_bf16_f32 v134, v140, v141
    v_cvt_pk_bf16_f32 v135, v142, v143
    s_cmp_ge_u32 s31, 2
    s_cbranch_scc1 L_ld_138
    s_waitcnt vmcnt(4)
    ds_add_u32 v245, v247 offset:0
L_ld_138:
    s_cmp_lg_u32 s50, 0
    s_cbranch_scc1 L_site_139
    s_mov_b32 s35, 4286578688
L_cl_140:
    v_cmp_gt_u32 vcc, 1, v253
    s_cbranch_vccz L_cok_141
    ds_read_b32 v253, v251 offset:316
    s_add_u32 s35, s35, 1
    s_waitcnt lgkmcnt(0)
    s_cbranch_scc0 L_cl_140
L_cok_141:
L_site_139:
    ds_read2_b32 v[252:253], v251 offset0:31 offset1:79
    ds_read_b128 v[56:59], v181 offset:0
    ds_read_b128 v[60:63], v181 offset:1024
    ds_read_b128 v[64:67], v180 offset:2048
    ds_read_b128 v[68:71], v180 offset:3072
    s_waitcnt lgkmcnt(5)
    v_mfma_f32_32x32x16_bf16 v[32:47], v[72:75], v[128:131], v[32:47]
    v_exp_f32 v144, v144
    v_exp_f32 v145, v145
    v_exp_f32 v146, v146
    v_exp_f32 v147, v147
    v_exp_f32 v148, v148
    v_mfma_f32_32x32x16_bf16 v[32:47], v[76:79], v[132:135], v[32:47]
    s_add_u32 m0, s52, 98304
    s_add_u32 s65, s34, 107520
    buffer_load_dwordx4 v248, s[12:15], s65 offen lds
    s_add_u32 m0, s52, 106496
    s_add_u32 s65, s34, 136192
    buffer_load_dwordx4 v248, s[12:15], s65 offen lds
    v_exp_f32 v149, v149
    v_exp_f32 v150, v150
    v_exp_f32 v151, v151
    v_exp_f32 v152, v152
    v_exp_f32 v153, v153
    s_waitcnt lgkmcnt(2)
    v_mfma_f32_32x32x16_bf16 v[160:175], v[56:59], v[16:19], 0
    v_exp_f32 v154, v154
    v_exp_f32 v155, v155
    v_exp_f32 v156, v156
    v_exp_f32 v157, v157
    v_exp_f32 v158, v158
    v_exp_f32 v159, v159
    v_mfma_f32_32x32x16_bf16 v[160:175], v[60:63], v[20:23], v[160:175]
    v_cvt_pk_bf16_f32 v144, v144, v145
    v_cvt_pk_bf16_f32 v145, v146, v147
    v_cvt_pk_bf16_f32 v146, v148, v149
    v_cvt_pk_bf16_f32 v147, v150, v151
    v_cvt_pk_bf16_f32 v148, v152, v153
    v_cvt_pk_bf16_f32 v149, v154, v155
    v_cvt_pk_bf16_f32 v150, v156, v157
    v_cvt_pk_bf16_f32 v151, v158, v159
    s_cmp_lg_u32 s50, 1
    s_cbranch_scc1 L_site_144
    s_mov_b32 s35, 4286578688
L_cl_145:
    v_cmp_gt_u32 vcc, 1, v253
    s_cbranch_vccz L_cok_146
    ds_read_b32 v253, v251 offset:316
    s_add_u32 s35, s35, 1
    s_waitcnt lgkmcnt(0)
    s_cbranch_scc0 L_cl_145
L_cok_146:
L_site_144:
    ds_read2_b32 v[252:253], v251 offset0:31 offset1:79
    ds_read_b128 v[48:51], v182 offset:0
    ds_read_b128 v[52:55], v182 offset:1024
    ds_read_b128 v[72:75], v181 offset:2048
    ds_read_b128 v[76:79], v181 offset:3072
    s_waitcnt lgkmcnt(5)
    v_mfma_f32_32x32x16_bf16 v[32:47], v[64:67], v[144:147], v[32:47]
    v_exp_f32 v160, v160
    v_exp_f32 v161, v161
    v_exp_f32 v162, v162
    v_exp_f32 v163, v163
    v_exp_f32 v164, v164
    v_mfma_f32_32x32x16_bf16 v[32:47], v[68:71], v[148:151], v[32:47]
    s_add_u32 m0, s52, 114688
    s_add_u32 s65, s34, 164864
    buffer_load_dwordx4 v248, s[12:15], s65 offen lds
    s_add_u32 m0, s52, 122880
    s_add_u32 s65, s34, 193536
    buffer_load_dwordx4 v248, s[12:15], s65 offen lds
    v_exp_f32 v165, v165
    v_exp_f32 v166, v166
    v_exp_f32 v167, v167
    v_exp_f32 v168, v168
    v_exp_f32 v169, v169
    s_waitcnt lgkmcnt(2)
    v_mfma_f32_32x32x16_bf16 v[128:143], v[48:51], v[16:19], 0
    v_exp_f32 v170, v170
    v_exp_f32 v171, v171
    v_exp_f32 v172, v172
    v_exp_f32 v173, v173
    v_exp_f32 v174, v174
    v_exp_f32 v175, v175
    v_mfma_f32_32x32x16_bf16 v[128:143], v[52:55], v[20:23], v[128:143]
    v_cvt_pk_bf16_f32 v160, v160, v161
    v_cvt_pk_bf16_f32 v161, v162, v163
    v_cvt_pk_bf16_f32 v162, v164, v165
    v_cvt_pk_bf16_f32 v163, v166, v167
    v_cvt_pk_bf16_f32 v164, v168, v169
    v_cvt_pk_bf16_f32 v165, v170, v171
    v_cvt_pk_bf16_f32 v166, v172, v173
    v_cvt_pk_bf16_f32 v167, v174, v175
    s_cmp_lg_u32 s50, 2
    s_cbranch_scc1 L_site_149
    s_mov_b32 s35, 4286578688
L_cl_150:
    v_cmp_gt_u32 vcc, 1, v253
    s_cbranch_vccz L_cok_151
    ds_read_b32 v253, v251 offset:316
    s_add_u32 s35, s35, 1
    s_waitcnt lgkmcnt(0)
    s_cbranch_scc0 L_cl_150
L_cok_151:
L_site_149:
    ds_read2_b32 v[252:253], v251 offset0:31 offset1:79
    ds_read_b128 v[56:59], v183 offset:0
    ds_read_b128 v[60:63], v183 offset:1024
    ds_read_b128 v[64:67], v182 offset:2048
    ds_read_b128 v[68:71], v182 offset:3072
    s_waitcnt lgkmcnt(5)
    v_mfma_f32_32x32x16_bf16 v[32:47], v[72:75], v[160:163], v[32:47]
    v_exp_f32 v128, v128
    v_exp_f32 v129, v129
    v_exp_f32 v130, v130
    v_exp_f32 v131, v131
    v_exp_f32 v132, v132
    v_mfma_f32_32x32x16_bf16 v[32:47], v[76:79], v[164:167], v[32:47]
    v_exp_f32 v133, v133
    v_exp_f32 v134, v134
    v_exp_f32 v135, v135
    v_exp_f32 v136, v136
    v_exp_f32 v137, v137
    s_waitcnt lgkmcnt(2)
    v_mfma_f32_32x32x16_bf16 v[144:159], v[56:59], v[16:19], 0
    v_exp_f32 v138, v138
    v_exp_f32 v139, v139
    v_exp_f32 v140, v140
    v_exp_f32 v141, v141
    v_exp_f32 v142, v142
    v_exp_f32 v143, v143
    v_mfma_f32_32x32x16_bf16 v[144:159], v[60:63], v[20:23], v[144:159]
    v_cvt_pk_bf16_f32 v128, v128, v129
    v_cvt_pk_bf16_f32 v129, v130, v131
    v_cvt_pk_bf16_f32 v130, v132, v133
    v_cvt_pk_bf16_f32 v131, v134, v135
    v_cvt_pk_bf16_f32 v132, v136, v137
    v_cvt_pk_bf16_f32 v133, v138, v139
    v_cvt_pk_bf16_f32 v134, v140, v141
    v_cvt_pk_bf16_f32 v135, v142, v143
    s_cmp_lg_u32 s50, 3
    s_cbranch_scc1 L_site_152
    s_mov_b32 s35, 4286578688
L_cl_153:
    v_cmp_gt_u32 vcc, 1, v253
    s_cbranch_vccz L_cok_154
    ds_read_b32 v253, v251 offset:316
    s_add_u32 s35, s35, 1
    s_waitcnt lgkmcnt(0)
    s_cbranch_scc0 L_cl_153
L_cok_154:
L_site_152:
    ds_read_b128 v[48:51], v184 offset:0
    ds_read_b128 v[52:55], v184 offset:1024
    ds_read_b128 v[72:75], v183 offset:2048
    ds_read_b128 v[76:79], v183 offset:3072
    s_waitcnt lgkmcnt(4)
    v_mfma_f32_32x32x16_bf16 v[32:47], v[64:67], v[128:131], v[32:47]
    v_exp_f32 v144, v144
    v_exp_f32 v145, v145
    v_exp_f32 v146, v146
    v_exp_f32 v147, v147
    v_exp_f32 v148, v148
    v_mfma_f32_32x32x16_bf16 v[32:47], v[68:71], v[132:135], v[32:47]
    v_exp_f32 v149, v149
    v_exp_f32 v150, v150
    v_exp_f32 v151, v151
    v_exp_f32 v152, v152
    v_exp_f32 v153, v153
    s_waitcnt lgkmcnt(2)
    v_mfma_f32_32x32x16_bf16 v[160:175], v[48:51], v[16:19], v[112:127]
    v_exp_f32 v154, v154
    v_exp_f32 v155, v155
    v_exp_f32 v156, v156
    v_exp_f32 v157, v157
    v_exp_f32 v158, v158
    v_exp_f32 v159, v159
    v_mfma_f32_32x32x16_bf16 v[160:175], v[52:55], v[20:23], v[160:175]
    v_cvt_pk_bf16_f32 v144, v144, v145
    v_cvt_pk_bf16_f32 v145, v146, v147
    v_cvt_pk_bf16_f32 v146, v148, v149
    v_cvt_pk_bf16_f32 v147, v150, v151
    v_cvt_pk_bf16_f32 v148, v152, v153
    v_cvt_pk_bf16_f32 v149, v154, v155
    v_cvt_pk_bf16_f32 v150, v156, v157
    v_cvt_pk_bf16_f32 v151, v158, v159
    ds_read_b128 v[64:67], v184 offset:2048
    ds_read_b128 v[68:71], v184 offset:3072
    s_waitcnt lgkmcnt(2)
    v_mfma_f32_32x32x16_bf16 v[32:47], v[72:75], v[144:147], v[32:47]
    v_exp_f32 v160, v160
    v_exp_f32 v161, v161
    v_exp_f32 v162, v162
    v_exp_f32 v163, v163
    v_exp_f32 v164, v164
    v_mfma_f32_32x32x16_bf16 v[32:47], v[76:79], v[148:151], v[32:47]
    v_exp_f32 v165, v165
    v_exp_f32 v166, v166
    v_exp_f32 v167, v167
    v_exp_f32 v168, v168
    v_exp_f32 v169, v169
    v_exp_f32 v170, v170
    v_exp_f32 v171, v171
    v_exp_f32 v172, v172
    v_exp_f32 v173, v173
    v_exp_f32 v174, v174
    v_exp_f32 v175, v175
    s_nop 0
    v_cvt_pk_bf16_f32 v160, v160, v161
    v_cvt_pk_bf16_f32 v161, v162, v163
    v_cvt_pk_bf16_f32 v162, v164, v165
    v_cvt_pk_bf16_f32 v163, v166, v167
    v_cvt_pk_bf16_f32 v164, v168, v169
    v_cvt_pk_bf16_f32 v165, v170, v171
    v_cvt_pk_bf16_f32 v166, v172, v173
    v_cvt_pk_bf16_f32 v167, v174, v175
    s_waitcnt lgkmcnt(0)
    s_nop 0
    v_mfma_f32_32x32x16_bf16 v[32:47], v[64:67], v[160:163], v[32:47]
    v_mfma_f32_32x32x16_bf16 v[32:47], v[68:71], v[164:167], v[32:47]
    s_nop 11
    v_mov_b32 v80, v44
    v_mov_b32 v81, v44
    s_nop 1
    v_permlane32_swap_b32 v80, v81
    s_nop 1
    s_mov_b32 s62, 0x5f800000
    v_cmp_ngt_f32 vcc, s62, v81
    s_cbranch_vccnz L_fb_155
L_aok_156:
    v_rcp_f32 v80, v81
    s_lshl_b32 s62, s28, 6
    s_lshl_b32 s63, s30, 2
    s_add_u32 s62, s62, s63
    v_cndmask_b32 v81, v80, 0, s[68:69]
    s_add_u32 s62, s62, s50
    s_mul_i32 s62, s62, 33280
    s_lshl_b32 s63, s29, 1
    s_add_u32 s63, s63, s51
    s_lshl_b32 s63, s63, 11
    s_add_u32 s62, s62, s63
    s_add_u32 s62, s62, 0xa00000
    v_mul_f32 v32, v80, v32
    v_mul_f32 v33, v80, v33
    v_mul_f32 v34, v80, v34
    v_mul_f32 v35, v80, v35
    v_mul_f32 v36, v80, v36
    v_mul_f32 v37, v80, v37
    v_mul_f32 v38, v80, v38
    v_mul_f32 v39, v80, v39
    v_cvt_pk_bf16_f32 v84, v32, v33
    v_cvt_pk_bf16_f32 v85, v34, v35
    v_cvt_pk_bf16_f32 v86, v36, v37
    v_cvt_pk_bf16_f32 v87, v38, v39
    buffer_store_dwordx4 v[84:87], v9, s[16:19], s62 offen offset:0 sc1
    v_mul_f32 v40, v80, v40
    v_mul_f32 v41, v80, v41
    v_mul_f32 v42, v80, v42
    v_mul_f32 v43, v80, v43
    v_mul_f32 v44, v81, v44
    v_mul_f32 v45, v81, v45
    v_mul_f32 v46, v81, v46
    v_mul_f32 v47, v81, v47
    v_cvt_pk_bf16_f32 v88, v40, v41
    v_cvt_pk_bf16_f32 v89, v42, v43
    v_cvt_pk_bf16_f32 v90, v44, v45
    v_cvt_pk_bf16_f32 v91, v46, v47
    buffer_store_dwordx4 v[88:91], v9, s[16:19], s62 offen offset:1024 sc1
L_p3:
    s_lshr_b32 s53, s31, 1
    s_and_b32 s57, s31, 1
    v_bfe_u32 v10, v1, 2, 2
    v_lshrrev_b32 v11, 5, v1
    v_lshl_add_u32 v11, v11, 2, v10
    v_lshlrev_b32 v11, 8, v11
    v_lshlrev_b32 v10, 6, v10
    v_and_b32 v12, 3, v1
    v_lshlrev_b32 v12, 3, v12
    v_and_b32 v6, 16, v1
    v_lshl_add_u32 v12, v6, 1, v12
    s_lshl_b32 s62, s53, 6
    v_add_u32 v12, s62, v12
    v_xor_b32 v12, v12, v10
    v_add_u32 v6, v11, v12
    v_add_u32 v4, 0x10000, v6
    v_add_u32 v5, 0x18000, v6
    s_lshr_b32 s62, s33, 1
    s_lshl_b32 s63, s28, 4
    s_add_u32 s62, s62, s63
    s_lshl_b32 s62, s62, 10
    s_add_u32 s62, s62, 0x1010000
    v_lshlrev_b32 v3, 7, v1
    v_add_u32 v3, s62, v3
    s_add_u32 s63, s63, s30
    s_lshl_b32 s63, s63, 3
    s_add_u32 s63, s63, s29
    s_lshl_b32 s63, s63, 7
    s_add_u32 s36, s63, 0x1010000
    s_lshr_b32 s64, s31, 2
    s_and_b32 s62, s31, 3
    s_lshl_b32 s62, s62, 11
    s_lshl_b32 s56, s64, 13
    s_add_u32 s56, s56, s62
    s_lshl_b32 s54, s28, 6
    s_lshl_b32 s63, s33, 1
    s_add_u32 s54, s54, s63
    s_add_u32 s54, s54, s64
    s_mul_i32 s54, s54, 33280
    s_add_u32 s54, s54, s62
    s_add_u32 s54, s54, 0xa00000
    s_lshl_b32 s62, s57, 13
    v_add_u32 v13, s62, v9
    v_add_u32 v14, 0x20000, v13
    v_add_u32 v13, 0x10000, v13
    v_and_b32 v10, 31, v1
    v_mul_u32_u24 v10, 272, v10
    v_lshrrev_b32 v11, 5, v1
    v_lshl_add_u32 v10, v11, 4, v10
    s_mul_i32 s62, s57, 8704
    s_lshl_b32 s63, s53, 6
    s_add_u32 s62, s62, s63
    v_add_u32 v58, s62, v10
    v_lshrrev_b32 v10, 4, v1
    v_and_b32 v11, 15, v1
    v_mul_u32_u24 v12, 272, v10
    v_lshl_add_u32 v12, v11, 4, v12
    s_mul_i32 s62, s31, 2176
    v_add_u32 v59, s62, v12
    v_mul_u32_u24 v12, 1792, v10
    v_lshl_add_u32 v12, v11, 4, v12
    s_cmp_eq_u32 s32, 3
    s_cselect_b32 s62, 8, 64
    v_mov_b32 v10, 0x7ff00000
    v_cmp_le_u32 vcc, s62, v11
    s_lshl_b32 s62, s33, 3
    s_add_u32 s62, s62, s31
    s_mul_i32 s67, s62, 14336
    v_cndmask_b32 v56, v12, v10, vcc
    v_add_u32 v57, 7168, v56
    s_mul_i32 s62, s28, 896
    s_add_u32 s67, s67, s62
    s_lshl_b32 s62, s32, 8
    s_add_u32 s67, s67, s62
    s_cmp_eq_u32 s28, 0
    s_cbranch_scc1 L_wa_157
    s_waitcnt vmcnt(7)
    s_branch L_wb_158
L_wa_157:
    s_waitcnt vmcnt(0)
L_wb_158:
    s_barrier
    s_cmp_lg_u32 s31, 0
    s_cbranch_scc1 L_nof_159
    s_mov_b64 exec, 1
    buffer_store_dwordx2 v[240:241], v15, s[16:19], s36 offen sc1
    s_mov_b64 exec, -1
L_nof_159:
    s_add_u32 m0, s52, 0
    s_add_u32 s65, s34, 222208
    buffer_load_dwordx4 v248, s[12:15], s65 offen lds
    s_add_u32 m0, s52, 8192
    s_add_u32 s65, s34, 250880
    buffer_load_dwordx4 v248, s[12:15], s65 offen lds
    s_add_u32 m0, s52, 16384
    s_add_u32 s65, s34, 279552
    buffer_load_dwordx4 v248, s[12:15], s65 offen lds
    s_add_u32 m0, s52, 24576
    s_add_u32 s65, s34, 308224
    buffer_load_dwordx4 v248, s[12:15], s65 offen lds
    s_add_u32 m0, s52, 32768
    s_add_u32 s65, s34, 336896
    buffer_load_dwordx4 v248, s[12:15], s65 offen lds
    s_add_u32 m0, s52, 40960
    s_add_u32 s65, s34, 365568
    buffer_load_dwordx4 v248, s[12:15], s65 offen lds
    s_add_u32 m0, s52, 49152
    s_add_u32 s65, s34, 394240
    buffer_load_dwordx4 v248, s[12:15], s65 offen lds
    s_cmp_eq_u32 s28, 0
    s_cbranch_scc1 L_early2_167
    s_waitcnt vmcnt(7)
    s_barrier
L_early2_167:
    ds_read_b64_tr_b16 v[96:97], v4 offset:0
    ds_read_b64_tr_b16 v[98:99], v4 offset:2048
    ds_read_b64_tr_b16 v[100:101], v4 offset:4096
    ds_read_b64_tr_b16 v[102:103], v4 offset:6144
    ds_read_b64_tr_b16 v[104:105], v4 offset:7168
    ds_read_b64_tr_b16 v[106:107], v4 offset:9216
    ds_read_b64_tr_b16 v[108:109], v4 offset:11264
    ds_read_b64_tr_b16 v[110:111], v4 offset:13312
    ds_read_b64_tr_b16 v[112:113], v4 offset:14336
    ds_read_b64_tr_b16 v[114:115], v4 offset:16384
    ds_read_b64_tr_b16 v[116:117], v4 offset:18432
    ds_read_b64_tr_b16 v[118:119], v4 offset:20480
    ds_read_b64_tr_b16 v[120:121], v4 offset:21504
    ds_read_b64_tr_b16 v[122:123], v4 offset:23552
    ds_read_b64_tr_b16 v[124:125], v4 offset:25600
    ds_read_b64_tr_b16 v[126:127], v4 offset:27648
    ds_read_b64_tr_b16 v[128:129], v4 offset:28672
    ds_read_b64_tr_b16 v[130:131], v5 offset:0
    ds_read_b64_tr_b16 v[132:133], v5 offset:2048
    ds_read_b64_tr_b16 v[134:135], v5 offset:4096
    ds_read_b64_tr_b16 v[136:137], v5 offset:5120
    ds_read_b64_tr_b16 v[138:139], v5 offset:7168
    ds_read_b64_tr_b16 v[140:141], v5 offset:9216
    ds_read_b64_tr_b16 v[142:143], v5 offset:11264
    ds_read_b64_tr_b16 v[144:145], v5 offset:12288
    ds_read_b64_tr_b16 v[146:147], v5 offset:14336
    ds_read_b64_tr_b16 v[148:149], v5 offset:16384
    ds_read_b64_tr_b16 v[150:151], v5 offset:18432
    ds_read_b64_tr_b16 v[152:153], v5 offset:19456
    ds_read_b64_tr_b16 v[154:155], v5 offset:21504
    ds_read_b64_tr_b16 v[156:157], v5 offset:23552
    ds_read_b64_tr_b16 v[158:159], v5 offset:25600
    ds_read_b64_tr_b16 v[160:161], v5 offset:26624
    ds_read_b64_tr_b16 v[162:163], v5 offset:28672
    ds_read_b64_tr_b16 v[164:165], v5 offset:30720
    s_cmp_lg_u32 s31, 7
    s_cbranch_scc1 L_np3_168
    s_mov_b64 exec, 0xff
    s_mov_b32 s35, 0
L_poll_169:
    buffer_load_dwordx2 v[242:243], v3, s[16:19], 0 offen sc1
    s_add_u32 s35, s35, 1
    s_waitcnt vmcnt(0)
    v_cmp_ne_u64 vcc, s[60:61], v[242:243]
    s_cmp_gt_u32 s35, 1048576
    s_cbranch_scc1 L_pok_170
    s_cbranch_vccnz L_poll_169
L_pok_170:
    s_mov_b64 exec, -1
L_np3_168:
    s_waitcnt vmcnt(0) lgkmcnt(0)
    s_barrier
    s_add_u32 m0, s56, 131072
    s_add_u32 s64, s54, 0
    buffer_load_dwordx4 v9, s[16:19], s64 offen offset:0 sc1 lds
    buffer_load_dwordx4 v9, s[16:19], s64 offen offset:1024 sc1 lds
    s_add_u32 m0, s56, 147456
    s_add_u32 s64, s54, 8192
    buffer_load_dwordx4 v9, s[16:19], s64 offen offset:0 sc1 lds
    buffer_load_dwordx4 v9, s[16:19], s64 offen offset:1024 sc1 lds
    s_add_u32 m0, s56, 65536
    s_add_u32 s64, s54, 16384
    buffer_load_dwordx4 v9, s[16:19], s64 offen offset:0 sc1 lds
    buffer_load_dwordx4 v9, s[16:19], s64 offen offset:1024 sc1 lds
    s_add_u32 m0, s56, 81920
    s_add_u32 s64, s54, 24576
    buffer_load_dwordx4 v9, s[16:19], s64 offen offset:0 sc1 lds
    buffer_load_dwordx4 v9, s[16:19], s64 offen offset:1024 sc1 lds
    ds_read_b64_tr_b16 v[166:167], v6 offset:0
    ds_read_b64_tr_b16 v[168:169], v6 offset:1024
    ds_read_b64_tr_b16 v[170:171], v6 offset:3072
    ds_read_b64_tr_b16 v[172:173], v6 offset:5120
    ds_read_b64_tr_b16 v[174:175], v6 offset:7168
    ds_read_b64_tr_b16 v[176:177], v6 offset:8192
    ds_read_b64_tr_b16 v[178:179], v6 offset:10240
    ds_read_b64_tr_b16 v[180:181], v6 offset:12288
    ds_read_b64_tr_b16 v[182:183], v6 offset:14336
    ds_read_b64_tr_b16 v[184:185], v6 offset:15360
    ds_read_b64_tr_b16 v[186:187], v6 offset:17408
    ds_read_b64_tr_b16 v[188:189], v6 offset:19456
    ds_read_b64_tr_b16 v[190:191], v6 offset:21504
    ds_read_b64_tr_b16 v[192:193], v6 offset:22528
    ds_read_b64_tr_b16 v[194:195], v6 offset:24576
    ds_read_b64_tr_b16 v[196:197], v6 offset:26624
    ds_read_b64_tr_b16 v[198:199], v6 offset:28672
    ds_read_b64_tr_b16 v[200:201], v6 offset:29696
    ds_read_b64_tr_b16 v[202:203], v6 offset:31744
    ds_read_b64_tr_b16 v[204:205], v6 offset:33792
    ds_read_b64_tr_b16 v[206:207], v6 offset:35840
    ds_read_b64_tr_b16 v[208:209], v6 offset:36864
    ds_read_b64_tr_b16 v[210:211], v6 offset:38912
    ds_read_b64_tr_b16 v[212:213], v6 offset:40960
    ds_read_b64_tr_b16 v[214:215], v6 offset:43008
    ds_read_b64_tr_b16 v[216:217], v6 offset:44032
    ds_read_b64_tr_b16 v[218:219], v6 offset:46080
    ds_read_b64_tr_b16 v[220:221], v6 offset:48128
    ds_read_b64_tr_b16 v[222:223], v6 offset:50176
    s_waitcnt vmcnt(6)
    s_barrier
    ds_read_b128 v[16:19], v14 offset:0
    ds_read_b128 v[20:23], v14 offset:1024
    ds_read_b128 v[24:27], v14 offset:2048
    s_waitcnt lgkmcnt(2)
    v_mfma_f32_32x32x16_bf16 v[32:47], v[96:99], v[16:19], 0
    ds_read_b128 v[28:31], v14 offset:3072
    s_waitcnt lgkmcnt(2)
    v_mfma_f32_32x32x16_bf16 v[32:47], v[100:103], v[20:23], v[32:47]
    ds_read_b128 v[16:19], v14 offset:4096
    s_waitcnt lgkmcnt(2)
    v_mfma_f32_32x32x16_bf16 v[32:47], v[104:107], v[24:27], v[32:47]
    ds_read_b128 v[20:23], v14 offset:5120
    s_waitcnt lgkmcnt(2)
    v_mfma_f32_32x32x16_bf16 v[32:47], v[108:111], v[28:31], v[32:47]
    ds_read_b128 v[24:27], v14 offset:6144
    s_waitcnt lgkmcnt(2)
    v_mfma_f32_32x32x16_bf16 v[32:47], v[112:115], v[16:19], v[32:47]
    ds_read_b128 v[28:31], v14 offset:7168
    s_waitcnt lgkmcnt(2)
    v_mfma_f32_32x32x16_bf16 v[32:47], v[116:119], v[20:23], v[32:47]
    s_waitcnt vmcnt(4)
    s_barrier
    ds_read_b128 v[16:19], v14 offset:16384
    s_waitcnt lgkmcnt(2)
    v_mfma_f32_32x32x16_bf16 v[32:47], v[120:123], v[24:27], v[32:47]
    ds_read_b128 v[20:23], v14 offset:17408
    s_waitcnt lgkmcnt(2)
    v_mfma_f32_32x32x16_bf16 v[32:47], v[124:127], v[28:31], v[32:47]
    ds_read_b128 v[24:27], v14 offset:18432
    s_waitcnt lgkmcnt(2)
    v_mfma_f32_32x32x16_bf16 v[32:47], v[128:131], v[16:19], v[32:47]
    ds_read_b128 v[28:31], v14 offset:19456
    s_waitcnt lgkmcnt(2)
    v_mfma_f32_32x32x16_bf16 v[32:47], v[132:135], v[20:23], v[32:47]
    ds_read_b128 v[16:19], v14 offset:20480
    s_waitcnt lgkmcnt(2)
    v_mfma_f32_32x32x16_bf16 v[32:47], v[136:139], v[24:27], v[32:47]
    ds_read_b128 v[20:23], v14 offset:21504
    s_waitcnt lgkmcnt(2)
    v_mfma_f32_32x32x16_bf16 v[32:47], v[140:143], v[28:31], v[32:47]
    ds_read_b128 v[24:27], v14 offset:22528
    s_waitcnt lgkmcnt(2)
    v_mfma_f32_32x32x16_bf16 v[32:47], v[144:147], v[16:19], v[32:47]
    ds_read_b128 v[28:31], v14 offset:23552
    s_waitcnt lgkmcnt(2)
    v_mfma_f32_32x32x16_bf16 v[32:47], v[148:151], v[20:23], v[32:47]
    s_waitcnt vmcnt(2)
    s_barrier
    ds_read_b128 v[16:19], v13 offset:0
    s_waitcnt lgkmcnt(2)
    v_mfma_f32_32x32x16_bf16 v[32:47], v[152:155], v[24:27], v[32:47]
    ds_read_b128 v[20:23], v13 offset:1024
    s_waitcnt lgkmcnt(2)
    v_mfma_f32_32x32x16_bf16 v[32:47], v[156:159], v[28:31], v[32:47]
    ds_read_b128 v[24:27], v13 offset:2048
    s_waitcnt lgkmcnt(2)
    v_mfma_f32_32x32x16_bf16 v[32:47], v[160:163], v[16:19], v[32:47]
    ds_read_b128 v[28:31], v13 offset:3072
    s_waitcnt lgkmcnt(2)
    v_mfma_f32_32x32x16_bf16 v[32:47], v[164:167], v[20:23], v[32:47]
    ds_read_b128 v[16:19], v13 offset:4096
    s_waitcnt lgkmcnt(2)
    v_mfma_f32_32x32x16_bf16 v[32:47], v[168:171], v[24:27], v[32:47]
    ds_read_b128 v[20:23], v13 offset:5120
    s_waitcnt lgkmcnt(2)
    v_mfma_f32_32x32x16_bf16 v[32:47], v[172:175], v[28:31], v[32:47]
    ds_read_b128 v[24:27], v13 offset:6144
    s_waitcnt lgkmcnt(2)
    v_mfma_f32_32x32x16_bf16 v[32:47], v[176:179], v[16:19], v[32:47]
    ds_read_b128 v[28:31], v13 offset:7168
    s_waitcnt lgkmcnt(2)
    v_mfma_f32_32x32x16_bf16 v[32:47], v[180:183], v[20:23], v[32:47]
    s_waitcnt vmcnt(0)
    s_barrier
    ds_read_b128 v[16:19], v13 offset:16384
    s_waitcnt lgkmcnt(2)
    v_mfma_f32_32x32x16_bf16 v[32:47], v[184:187], v[24:27], v[32:47]
    ds_read_b128 v[20:23], v13 offset:17408
    s_waitcnt lgkmcnt(2)
    v_mfma_f32_32x32x16_bf16 v[32:47], v[188:191], v[28:31], v[32:47]
    ds_read_b128 v[24:27], v13 offset:18432
    s_waitcnt lgkmcnt(2)
    v_mfma_f32_32x32x16_bf16 v[32:47], v[192:195], v[16:19], v[32:47]
    ds_read_b128 v[28:31], v13 offset:19456
    s_waitcnt lgkmcnt(2)
    v_mfma_f32_32x32x16_bf16 v[32:47], v[196:199], v[20:23], v[32:47]
    ds_read_b128 v[16:19], v13 offset:20480
    s_waitcnt lgkmcnt(2)
    v_mfma_f32_32x32x16_bf16 v[32:47], v[200:203], v[24:27], v[32:47]
    ds_read_b128 v[20:23], v13 offset:21504
    s_waitcnt lgkmcnt(2)
    v_mfma_f32_32x32x16_bf16 v[32:47], v[204:207], v[28:31], v[32:47]
    ds_read_b128 v[24:27], v13 offset:22528
    s_waitcnt lgkmcnt(2)
    v_mfma_f32_32x32x16_bf16 v[32:47], v[208:211], v[16:19], v[32:47]
    ds_read_b128 v[28:31], v13 offset:23552
    s_waitcnt lgkmcnt(2)
    v_mfma_f32_32x32x16_bf16 v[32:47], v[212:215], v[20:23], v[32:47]
    s_waitcnt lgkmcnt(1)
    v_mfma_f32_32x32x16_bf16 v[32:47], v[216:219], v[24:27], v[32:47]
    s_waitcnt lgkmcnt(0)
    v_mfma_f32_32x32x16_bf16 v[32:47], v[220:223], v[28:31], v[32:47]
    s_nop 11
    v_cvt_pk_bf16_f32 v48, v32, v33
    v_cvt_pk_bf16_f32 v49, v34, v35
    v_cvt_pk_bf16_f32 v50, v36, v37
    v_cvt_pk_bf16_f32 v51, v38, v39
    v_cvt_pk_bf16_f32 v52, v40, v41
    v_cvt_pk_bf16_f32 v53, v42, v43
    v_cvt_pk_bf16_f32 v54, v44, v45
    v_cvt_pk_bf16_f32 v55, v46, v47
    s_nop 1
    v_permlane32_swap_b32 v48, v50
    v_permlane32_swap_b32 v49, v51
    v_permlane32_swap_b32 v52, v54
    v_permlane32_swap_b32 v53, v55
    s_nop 1
    ds_write_b128 v58, v[48:51] offset:0
    ds_write_b128 v58, v[52:55] offset:32
    s_waitcnt lgkmcnt(0)
    s_barrier
    ds_read_b128 v[48:51], v59 offset:0
    ds_read_b128 v[52:55], v59 offset:1088
    s_waitcnt lgkmcnt(1)
    buffer_store_dwordx4 v[48:51], v56, s[20:23], s67 offen sc1
    s_waitcnt lgkmcnt(0)
    buffer_store_dwordx4 v[52:55], v57, s[20:23], s67 offen sc1
L_end:
    s_endpgm
L_fb_155:
    s_lshl_b32 s63, s30, 2
    s_add_u32 s63, s63, s50
    v_mov_b32 v81, 0
    v_cndmask_b32 v22, v22, v81, s[68:69]
    v_mov_b32 v80, 0xf149f2ca
    v_mov_b32 v32, 0
    v_mov_b32 v33, 0
    v_mov_b32 v34, 0
    v_mov_b32 v35, 0
    v_mov_b32 v36, 0
    v_mov_b32 v37, 0
    v_mov_b32 v38, 0
    v_mov_b32 v39, 0
    v_mov_b32 v40, 0
    v_mov_b32 v41, 0
    v_mov_b32 v42, 0
    v_mov_b32 v43, 0
    v_mov_b32 v44, 0
    v_mov_b32 v45, 0
    v_mov_b32 v46, 0
    v_mov_b32 v47, 0
    s_mov_b32 s67, 0
L_fbl_171:
    s_add_u32 s62, s50, 8
    s_sub_u32 s62, s62, s67
    s_lshr_b32 s64, s62, 2
    s_mul_i32 s64, s64, 33280
    s_and_b32 s62, s62, 3
    s_lshl_b32 s62, s62, 12
    s_add_u32 s62, s62, s64
    s_lshl_b32 s64, s51, 14
    s_add_u32 s62, s62, s64
    s_add_u32 s62, s62, s37
    s_sub_u32 s62, s62, 66560
    buffer_load_dwordx4 v[48:51], v9, s[16:19], s62 offen offset:0 sc1
    buffer_load_dwordx4 v[52:55], v9, s[16:19], s62 offen offset:1024 sc1
    buffer_load_dwordx4 v[56:59], v9, s[16:19], s62 offen offset:2048 sc1
    buffer_load_dwordx4 v[60:63], v9, s[16:19], s62 offen offset:3072 sc1
    s_waitcnt vmcnt(0)
    s_cmp_eq_u32 s67, 0
    s_cbranch_scc1 L_fb0_172
    s_cmp_eq_u32 s67, 8
    s_cbranch_scc1 L_fb8_173
    v_mfma_f32_32x32x16_bf16 v[128:143], v[48:51], v[16:19], 0
    s_branch L_fbj_174
L_fb0_172:
    v_mfma_f32_32x32x16_bf16 v[128:143], v[48:51], v[16:19], v[96:111]
    s_branch L_fbj_174
L_fb8_173:
    v_mfma_f32_32x32x16_bf16 v[128:143], v[48:51], v[16:19], v[112:127]
L_fbj_174:
    v_mfma_f32_32x32x16_bf16 v[128:143], v[52:55], v[20:23], v[128:143]
    s_nop 11
    v_max3_f32 v80, v80, v128, v129
    v_max3_f32 v80, v80, v130, v131
    v_max3_f32 v80, v80, v132, v133
    v_max3_f32 v80, v80, v134, v135
    v_max3_f32 v80, v80, v136, v137
    v_max3_f32 v80, v80, v138, v139
    v_max3_f32 v80, v80, v140, v141
    v_max3_f32 v80, v80, v142, v143
    s_add_u32 s67, s67, 1
    s_min_u32 s62, s63, 8
    s_cmp_le_u32 s67, s62
    s_cbranch_scc1 L_fbl_171
    v_mov_b32 v81, v80
    s_nop 1
    v_permlane32_swap_b32 v80, v81
    s_nop 1
    v_max_f32 v80, v80, v81
    v_cvt_pk_bf16_f32 v81, -v80, 0
    v_lshlrev_b32 v82, 16, v81
    v_cndmask_b32 v22, v22, v81, s[68:69]
    s_nop 1
    s_mov_b32 s67, 0
L_fbl_175:
    s_add_u32 s62, s50, 8
    s_sub_u32 s62, s62, s67
    s_lshr_b32 s64, s62, 2
    s_mul_i32 s64, s64, 33280
    s_and_b32 s62, s62, 3
    s_lshl_b32 s62, s62, 12
    s_add_u32 s62, s62, s64
    s_lshl_b32 s64, s51, 14
    s_add_u32 s62, s62, s64
    s_add_u32 s62, s62, s37
    s_sub_u32 s62, s62, 66560
    buffer_load_dwordx4 v[48:51], v9, s[16:19], s62 offen offset:0 sc1
    buffer_load_dwordx4 v[52:55], v9, s[16:19], s62 offen offset:1024 sc1
    buffer_load_dwordx4 v[56:59], v9, s[16:19], s62 offen offset:2048 sc1
    buffer_load_dwordx4 v[60:63], v9, s[16:19], s62 offen offset:3072 sc1
    s_waitcnt vmcnt(0)
    s_cmp_eq_u32 s67, 0
    s_cbranch_scc1 L_fb0_176
    s_cmp_eq_u32 s67, 8
    s_cbranch_scc1 L_fb8_177
    v_mfma_f32_32x32x16_bf16 v[128:143], v[48:51], v[16:19], 0
    s_branch L_fbj_178
L_fb0_176:
    v_mfma_f32_32x32x16_bf16 v[128:143], v[48:51], v[16:19], v[96:111]
    s_branch L_fbj_178
L_fb8_177:
    v_mfma_f32_32x32x16_bf16 v[128:143], v[48:51], v[16:19], v[112:127]
L_fbj_178:
    v_mfma_f32_32x32x16_bf16 v[128:143], v[52:55], v[20:23], v[128:143]
    s_nop 11
    v_exp_f32 v128, v128
    v_exp_f32 v129, v129
    v_exp_f32 v130, v130
    v_exp_f32 v131, v131
    v_exp_f32 v132, v132
    v_exp_f32 v133, v133
    v_exp_f32 v134, v134
    v_exp_f32 v135, v135
    v_exp_f32 v136, v136
    v_exp_f32 v137, v137
    v_exp_f32 v138, v138
    v_exp_f32 v139, v139
    v_exp_f32 v140, v140
    v_exp_f32 v141, v141
    v_exp_f32 v142, v142
    v_exp_f32 v143, v143
    s_nop 0
    v_cvt_pk_bf16_f32 v128, v128, v129
    v_cvt_pk_bf16_f32 v129, v130, v131
    v_cvt_pk_bf16_f32 v130, v132, v133
    v_cvt_pk_bf16_f32 v131, v134, v135
    v_cvt_pk_bf16_f32 v132, v136, v137
    v_cvt_pk_bf16_f32 v133, v138, v139
    v_cvt_pk_bf16_f32 v134, v140, v141
    v_cvt_pk_bf16_f32 v135, v142, v143
    s_nop 1
    v_mfma_f32_32x32x16_bf16 v[32:47], v[56:59], v[128:131], v[32:47]
    v_mfma_f32_32x32x16_bf16 v[32:47], v[60:63], v[132:135], v[32:47]
    s_nop 11
    s_add_u32 s67, s67, 1
    s_min_u32 s62, s63, 8
    s_cmp_le_u32 s67, s62
    s_cbranch_scc1 L_fbl_175
    v_mov_b32 v80, v44
    v_mov_b32 v81, v44
    s_nop 1
    v_permlane32_swap_b32 v80, v81
    s_nop 1
    s_branch L_aok_156
L_codeend:
.section .rodata,"a"
.p2align 6
.amdhsa_kernel concat_heads__sliding_block__sliding_local_dilated__prompt_kernel
  .amdhsa_next_free_vgpr 256
  .amdhsa_next_free_sgpr 102
  .amdhsa_accum_offset 256
  .amdhsa_group_segment_fixed_size 0
  .amdhsa_kernarg_size 72
  .amdhsa_user_sgpr_count 2
  .amdhsa_user_sgpr_kernarg_segment_ptr 1
  .amdhsa_system_sgpr_workgroup_id_x 1
.end_amdhsa_kernel
```
